```python
import torch

def _softmax(x, axis=-1):
    return torch.softmax(x, dim=axis)
def _gelu(x):
    return torch.nn.functional.gelu(x, approximate="tanh")
def _silu(x):
    return torch.nn.functional.silu(x)
def _sigmoid(x):
    return torch.sigmoid(x)
def _layernorm(x, axis=-1, eps=1e-5):
    m = x.mean(dim=axis, keepdim=True)
    v = x.var(dim=axis, keepdim=True, unbiased=False)
    return (x - m) / torch.sqrt(v + eps)
def _scatter_add(tgt, idx, src, axis=0):
    return tgt.clone().index_add_(axis, idx, src)
def _segment_sum(src, seg, n):
    out = torch.zeros((n,) + src.shape[1:], dtype=src.dtype)
    return out.index_add_(0, seg, src)
def _pad(x, pw):
    flat = tuple(v for pair in reversed(pw) for v in pair)
    return torch.nn.functional.pad(x, flat)

kernel_name = 'standalone__gqa_softmax__near_ridge'

def setup_inputs():

    _w = (lambda a: (lambda t: t.to(torch.bfloat16) if t.is_floating_point() else t)(torch.as_tensor(a)))
    B, Hq, Hkv, Sq, Sk, D = 64, 32, 32, 256, 256, 128
    return {
        "q": _w((lambda *s: torch.randn(*s, dtype=torch.bfloat16) * 0.8)(B, Hq, Sq, D)),
        "k": _w((lambda *s: torch.randn(*s, dtype=torch.bfloat16) * 0.8)(B, Hkv, Sk, D)),
        "v": _w((lambda *s: torch.randn(*s, dtype=torch.bfloat16) * 0.05)(B, Hkv, Sk, D)),
    }

def reference(q, k, v):
    B, Hq, Sq, D = q.shape
    Hkv = k.shape[1]
    rep = Hq // Hkv
    k = (lambda x, n, axis: torch.repeat_interleave(x, n, dim=axis))(k, rep, axis=1)
    v = (lambda x, n, axis: torch.repeat_interleave(x, n, dim=axis))(v, rep, axis=1)
    scale = D ** -0.5
    scores = torch.einsum("bhqd,bhkd->bhqk", q, k) * scale
    p = _softmax(scores, axis=-1)
    return torch.einsum("bhqk,bhkd->bhqd", p, v)
```

```asm
; @launch grid=(256,1,1) block=(256,1,1) lds=163840
.amdgcn_target "amdgcn-amd-amdhsa--gfx950"
.text
.globl standalone__gqa_softmax__near_ridge_kernel
.p2align 8
.type standalone__gqa_softmax__near_ridge_kernel,@function
standalone__gqa_softmax__near_ridge_kernel:
    s_cmp_ge_u32 s2, 256
    s_cbranch_scc1 L_end
    s_load_dwordx4 s[32:35], s[0:1], 0
    s_load_dwordx4 s[36:39], s[0:1], 16
    v_and_b32 v229, 63, v0
    v_lshrrev_b32 v230, 6, v0
    v_lshrrev_b32 v231, 4, v229
    v_readfirstlane_b32 s30, v230
    v_and_b32 v232, 15, v229
    v_lshl_add_u32 v233, v230, 4, v231
    v_lshlrev_b32 v208, 8, v233
    v_xor_b32 v233, v231, v232
    v_lshl_add_u32 v204, v233, 4, v208
    v_xor_b32 v205, 64, v204
    v_xor_b32 v206, 128, v204
    v_xor_b32 v207, 192, v204
    s_lshl_b32 s20, s2, 16
    s_lshl_b32 s24, s30, 12
    s_waitcnt lgkmcnt(0)
    s_mov_b32 s4, s32
    s_and_b32 s5, s33, 0xffff
    s_mov_b32 s6, 0x8000000
    s_mov_b32 s7, 0x20000
    s_mov_b32 s8, s34
    s_and_b32 s9, s35, 0xffff
    s_mov_b32 s10, 0x8000000
    s_mov_b32 s11, 0x20000
    s_mov_b32 s12, s36
    s_and_b32 s13, s37, 0xffff
    s_mov_b32 s14, 0x8000000
    s_mov_b32 s15, 0x20000
    buffer_load_dword v248, v204, s[8:11], s20 offen
    buffer_load_dword v249, v204, s[12:15], s20 offen
    s_xor_b32 m0, s24, 0x0
    s_add_u32 s23, s20, 0x0
    buffer_load_dwordx4 v204, s[4:7], s23 offen nt lds
    buffer_load_dwordx4 v205, s[4:7], s23 offen offset:1024 nt lds
    buffer_load_dwordx4 v206, s[4:7], s23 offen offset:2048 nt lds
    buffer_load_dwordx4 v207, s[4:7], s23 offen offset:3072 nt lds
    s_xor_b32 m0, s24, 0x4000
    s_add_u32 s23, s20, 0x4000
    buffer_load_dwordx4 v204, s[4:7], s23 offen nt lds
    buffer_load_dwordx4 v205, s[4:7], s23 offen offset:1024 nt lds
    buffer_load_dwordx4 v206, s[4:7], s23 offen offset:2048 nt lds
    buffer_load_dwordx4 v207, s[4:7], s23 offen offset:3072 nt lds
    s_xor_b32 m0, s24, 0x8000
    s_add_u32 s23, s20, 0x8000
    buffer_load_dwordx4 v204, s[4:7], s23 offen nt lds
    buffer_load_dwordx4 v205, s[4:7], s23 offen offset:1024 nt lds
    buffer_load_dwordx4 v206, s[4:7], s23 offen offset:2048 nt lds
    buffer_load_dwordx4 v207, s[4:7], s23 offen offset:3072 nt lds
    s_xor_b32 m0, s24, 0x10000
    s_add_u32 s23, s20, 0x0
    buffer_load_dwordx4 v204, s[8:11], s23 offen nt lds
    buffer_load_dwordx4 v205, s[8:11], s23 offen offset:1024 nt lds
    buffer_load_dwordx4 v206, s[8:11], s23 offen offset:2048 nt lds
    buffer_load_dwordx4 v207, s[8:11], s23 offen offset:3072 nt lds
    s_xor_b32 m0, s24, 0xc000
    s_add_u32 s23, s20, 0xc000
    buffer_load_dwordx4 v204, s[4:7], s23 offen nt lds
    buffer_load_dwordx4 v205, s[4:7], s23 offen offset:1024 nt lds
    buffer_load_dwordx4 v206, s[4:7], s23 offen offset:2048 nt lds
    buffer_load_dwordx4 v207, s[4:7], s23 offen offset:3072 nt lds
    v_lshlrev_b32 v233, 1, v231
    v_xor_b32 v233, v233, v232
    v_lshl_add_u32 v208, v233, 4, v208
    v_xor_b32 v209, 128, v208
    s_xor_b32 m0, s24, 0x14000
    s_add_u32 s23, s20, 0x0
    buffer_load_dwordx4 v208, s[12:15], s23 offen nt lds
    buffer_load_dwordx4 v209, s[12:15], s23 offen offset:1024 nt lds
    buffer_load_dwordx4 v208, s[12:15], s23 offen offset:2048 nt lds
    buffer_load_dwordx4 v209, s[12:15], s23 offen offset:3072 nt lds
    s_getpc_b64 s[46:47]
L_pf:
    v_lshlrev_b32 v250, 7, v0
    v_min_u32 v250, L_end-L_pf, v250
    v_mov_b32 v253, s47
    v_add_co_u32 v252, vcc, s46, v250
    s_nop 1
    v_addc_co_u32 v253, vcc, 0, v253, vcc
    global_load_dword v251, v[252:253], off
    s_lshl_b32 s25, s30, 14
    s_or_b32 s25, s25, 0x10000
    s_add_u32 s21, s20, 0x1000000
    s_mov_b32 s22, 0
    s_mov_b32 s29, 0
    s_mov_b32 s31, 0
    s_mov_b32 s44, 0
    s_mov_b32 s27, 0
    s_mov_b32 s26, 8
    s_mov_b32 s28, 0x3e0293ee
    s_mov_b32 s16, s38
    s_and_b32 s17, s39, 0xffff
    s_mov_b32 s18, 0x0
    s_mov_b32 s19, 0x20000
    s_mov_b32 s72, s32
    s_and_b32 s73, s33, 0xffff
    s_mov_b32 s74, 0x8000000
    s_mov_b32 s75, 0x20000
    s_mov_b32 s76, s34
    s_and_b32 s77, s35, 0xffff
    s_mov_b32 s78, 0x8000000
    s_mov_b32 s79, 0x20000
    s_mov_b32 s80, s36
    s_and_b32 s81, s37, 0xffff
    s_mov_b32 s82, 0x8000000
    s_mov_b32 s83, 0x20000
    buffer_store_dword v204, v204, s[16:19], 0 offen
    v_xor_b32 v233, v231, v232
    v_lshlrev_b32 v233, 4, v233
    v_lshl_add_u32 v233, v232, 8, v233
    v_add_u32 v192, 0x10000, v233
    v_xor_b32 v193, 0x40, v192
    v_xor_b32 v194, 0x80, v192
    v_xor_b32 v195, 0xc0, v192
    v_bfe_u32 v233, v229, 2, 2
    v_lshl_add_u32 v233, v231, 2, v233
    v_and_b32 v232, 7, v233
    v_lshlrev_b32 v233, 8, v233
    v_lshl_add_u32 v233, v232, 5, v233
    v_and_b32 v232, 3, v229
    v_lshl_add_u32 v233, v232, 3, v233
    v_add_u32 v196, 0x10000, v233
    v_xor_b32 v197, 0x20, v196
    v_xor_b32 v198, 0x40, v196
    v_xor_b32 v199, 0x60, v196
    v_xor_b32 v200, 0x80, v196
    v_xor_b32 v201, 0xa0, v196
    v_xor_b32 v202, 0xc0, v196
    v_xor_b32 v203, 0xe0, v196
    v_and_b32 v232, 15, v229
    v_lshlrev_b32 v233, 7, v232
    v_and_b32 v232, 7, v229
    v_lshrrev_b32 v210, 1, v231
    v_xor_b32 v232, v232, v210
    v_lshl_add_u32 v233, v232, 4, v233
    v_and_b32 v232, 1, v231
    v_lshl_add_u32 v233, v232, 3, v233
    v_lshl_add_u32 v233, v230, 13, v233
    v_add_u32 v210, 0x20000, v233
    v_and_b32 v231, 7, v229
    v_lshrrev_b32 v232, 3, v229
    v_xor_b32 v233, v231, v232
    v_lshlrev_b32 v233, 4, v233
    v_lshl_add_u32 v233, v232, 7, v233
    v_lshl_add_u32 v233, v230, 13, v233
    v_add_u32 v211, 0x20000, v233
    v_lshl_add_u32 v232, v230, 6, v232
    v_lshlrev_b32 v232, 8, v232
    v_lshl_add_u32 v212, v231, 4, v232
    v_mov_b32 v233, 0x3f803f80
    v_accvgpr_write_b32 a128, v233
    v_accvgpr_write_b32 a129, v233
    v_accvgpr_write_b32 a130, v233
    v_accvgpr_write_b32 a131, v233
    v_mov_b32 v233, 0x7f000000
    v_mov_b32 v217, v233
    v_mov_b32 v218, v233
    v_mov_b32 v219, v233
    v_mov_b32 v220, v233
    v_mov_b32 v128, 0
    v_mov_b32 v129, 0
    v_mov_b32 v130, 0
    v_mov_b32 v131, 0
    v_mov_b32 v132, 0
    v_mov_b32 v133, 0
    v_mov_b32 v134, 0
    v_mov_b32 v135, 0
    v_mov_b32 v136, 0
    v_mov_b32 v137, 0
    v_mov_b32 v138, 0
    v_mov_b32 v139, 0
    v_mov_b32 v140, 0
    v_mov_b32 v141, 0
    v_mov_b32 v142, 0
    v_mov_b32 v143, 0
    v_mov_b32 v144, 0
    v_mov_b32 v145, 0
    v_mov_b32 v146, 0
    v_mov_b32 v147, 0
    v_mov_b32 v148, 0
    v_mov_b32 v149, 0
    v_mov_b32 v150, 0
    v_mov_b32 v151, 0
    v_mov_b32 v152, 0
    v_mov_b32 v153, 0
    v_mov_b32 v154, 0
    v_mov_b32 v155, 0
    v_mov_b32 v156, 0
    v_mov_b32 v157, 0
    v_mov_b32 v158, 0
    v_mov_b32 v159, 0
    v_mov_b32 v160, 0
    v_mov_b32 v161, 0
    v_mov_b32 v162, 0
    v_mov_b32 v163, 0
    v_mov_b32 v164, 0
    v_mov_b32 v165, 0
    v_mov_b32 v166, 0
    v_mov_b32 v167, 0
    v_mov_b32 v168, 0
    v_mov_b32 v169, 0
    v_mov_b32 v170, 0
    v_mov_b32 v171, 0
    v_mov_b32 v172, 0
    v_mov_b32 v173, 0
    v_mov_b32 v174, 0
    v_mov_b32 v175, 0
    v_mov_b32 v176, 0
    v_mov_b32 v177, 0
    v_mov_b32 v178, 0
    v_mov_b32 v179, 0
    v_mov_b32 v180, 0
    v_mov_b32 v181, 0
    v_mov_b32 v182, 0
    v_mov_b32 v183, 0
    v_mov_b32 v184, 0
    v_mov_b32 v185, 0
    v_mov_b32 v186, 0
    v_mov_b32 v187, 0
    v_mov_b32 v188, 0
    v_mov_b32 v189, 0
    v_mov_b32 v190, 0
    v_mov_b32 v191, 0
    v_mov_b32 v213, 0x43480000
    v_mov_b32 v214, 0x43480000
    v_mov_b32 v215, 0x43480000
    v_mov_b32 v216, 0x43480000
L_loop:
    s_waitcnt vmcnt(6) lgkmcnt(0)
    s_barrier
    v_xor_b32 v241, s25, v192
    v_xor_b32 v242, s25, v193
    v_xor_b32 v243, s25, v194
    v_xor_b32 v244, s25, v195
    v_mfma_f32_16x16x32_bf16 v[16:19], a[100:103], v[128:131], v[16:19]
    ds_read_b128 a[0:3], v241 offset:0
    ds_read_b64_tr_b16 a[114:115], v200 offset:53248
    v_max3_f32 v229, v160, v161, v162
    v_max3_f32 v230, v168, v169, v170
    v_max3_f32 v231, v176, v177, v178
    v_mfma_f32_16x16x32_bf16 v[20:23], a[100:103], v[132:135], v[20:23]
    ds_read_b128 a[4:7], v242 offset:0
    v_max3_f32 v232, v184, v185, v186
    v_max3_f32 v229, v229, v163, v164
    v_max3_f32 v230, v230, v171, v172
    v_mfma_f32_16x16x32_bf16 v[24:27], a[100:103], v[136:139], v[24:27]
    ds_read_b128 a[8:11], v243 offset:0
    s_cmp_eq_u32 s26, 1
    s_cselect_b32 s74, 0, 0x8000000
    s_cselect_b32 s78, 0, 0x8000000
    s_cselect_b32 s82, 0, 0x8000000
    v_max3_f32 v231, v231, v179, v180
    v_max3_f32 v232, v232, v187, v188
    v_mfma_f32_16x16x32_bf16 v[28:31], a[100:103], v[140:143], v[28:31]
    ds_read_b128 a[12:15], v244 offset:0
    v_max3_f32 v229, v229, v165, v166
    v_max3_f32 v230, v230, v173, v174
    v_max3_f32 v231, v231, v181, v182
    v_mfma_f32_16x16x32_bf16 v[32:35], a[104:107], v[128:131], v[32:35]
    ds_read_b128 a[16:19], v241 offset:4096
    ds_read_b64_tr_b16 a[116:117], v201 offset:49152
    s_xor_b32 m0, s24, 0x18000
    s_add_u32 s23, s20, 0x4000
    buffer_load_dwordx4 v204, s[8:11], s23 offen nt lds
    v_max3_f32 v232, v232, v189, v190
    v_max_f32 v229, v229, v167
    v_max_f32 v230, v230, v175
    v_mfma_f32_16x16x32_bf16 v[36:39], a[104:107], v[132:135], v[36:39]
    ds_read_b128 a[20:23], v242 offset:4096
    ds_read_b64_tr_b16 a[118:119], v201 offset:53248
    v_max_f32 v231, v231, v183
    v_max_f32 v232, v232, v191
    v_mfma_f32_16x16x32_bf16 a[136:139], a[128:131], v[132:135], a[136:139]
    ds_read_b128 a[24:27], v243 offset:4096
    buffer_load_dwordx4 v205, s[8:11], s23 offen offset:1024 nt lds
    v_cmp_gt_f32 s[32:33], v229, v217
    v_cmp_gt_f32 s[34:35], v230, v218
    v_mfma_f32_16x16x32_bf16 v[40:43], a[104:107], v[136:139], v[40:43]
    ds_read_b128 a[28:31], v244 offset:4096
    v_cmp_gt_f32 s[36:37], v231, v219
    v_cmp_gt_f32 s[38:39], v232, v220
    v_mfma_f32_16x16x32_bf16 v[44:47], a[104:107], v[140:143], v[44:47]
    ds_read_b128 a[32:35], v241 offset:8192
    ds_read_b64_tr_b16 a[120:121], v202 offset:49152
    buffer_load_dwordx4 v206, s[8:11], s23 offen offset:2048 nt lds
    s_or_b64 s[32:33], s[32:33], s[34:35]
    s_or_b64 s[36:37], s[36:37], s[38:39]
    v_mfma_f32_16x16x32_bf16 v[48:51], a[108:111], v[128:131], v[48:51]
    ds_read_b128 a[36:39], v242 offset:8192
    ds_read_b64_tr_b16 a[122:123], v202 offset:53248
    s_or_b64 s[32:33], s[32:33], s[36:37]
    s_cbranch_scc1 L_rb6
L_rbr6:
    v_mfma_f32_16x16x32_bf16 v[52:55], a[108:111], v[132:135], v[52:55]
    s_waitcnt lgkmcnt(14)
    ds_read_b128 a[40:43], v243 offset:8192
    buffer_load_dwordx4 v207, s[8:11], s23 offen offset:3072 nt lds
    v_fma_f32 v160, v160, s28, -v213
    v_fma_f32 v161, v161, s28, -v213
    v_mfma_f32_16x16x32_bf16 v[56:59], a[108:111], v[136:139], v[56:59]
    s_waitcnt lgkmcnt(14)
    ds_read_b128 a[44:47], v244 offset:8192
    v_exp_f32 v160, v160
    v_fma_f32 v162, v162, s28, -v213
    v_mfma_f32_16x16x32_bf16 v[60:63], a[108:111], v[140:143], v[60:63]
    s_waitcnt lgkmcnt(14)
    ds_read_b128 a[48:51], v241 offset:12288
    v_exp_f32 v161, v161
    v_mfma_f32_16x16x32_bf16 v[64:67], a[112:115], v[128:131], v[64:67]
    s_waitcnt lgkmcnt(14)
    ds_read_b128 a[52:55], v242 offset:12288
    s_waitcnt lgkmcnt(14)
    ds_read_b64_tr_b16 a[124:125], v203 offset:49152
    v_fma_f32 v163, v163, s28, -v213
    v_exp_f32 v162, v162
    v_mfma_f32_16x16x32_bf16 v[68:71], a[112:115], v[132:135], v[68:71]
    s_waitcnt lgkmcnt(14)
    ds_read_b128 a[56:59], v243 offset:12288
    s_waitcnt lgkmcnt(14)
    ds_read_b64_tr_b16 a[126:127], v203 offset:53248
    v_fma_f32 v164, v164, s28, -v213
    v_mfma_f32_16x16x32_bf16 a[140:143], a[128:131], v[136:139], a[140:143]
    s_waitcnt lgkmcnt(14)
    ds_read_b128 a[60:63], v244 offset:12288
    v_exp_f32 v163, v163
    v_fma_f32 v165, v165, s28, -v213
    v_mfma_f32_16x16x32_bf16 v[72:75], a[112:115], v[136:139], v[72:75]
    v_cvt_pk_bf16_f32 v160, v160, v161
    v_mfma_f32_16x16x32_bf16 v[76:79], a[112:115], v[140:143], v[76:79]
    s_waitcnt lgkmcnt(14)
    ds_read_b128 a[64:67], v192 offset:0
    v_exp_f32 v164, v164
    v_fma_f32 v166, v166, s28, -v213
    v_mfma_f32_16x16x32_bf16 v[80:83], a[116:119], v[128:131], v[80:83]
    s_waitcnt lgkmcnt(14)
    ds_read_b128 a[68:71], v193 offset:0
    v_exp_f32 v165, v165
    v_fma_f32 v167, v167, s28, -v213
    v_mfma_f32_16x16x32_bf16 v[84:87], a[116:119], v[132:135], v[84:87]
    s_waitcnt lgkmcnt(14)
    ds_read_b128 a[72:75], v194 offset:0
    v_cvt_pk_bf16_f32 v161, v162, v163
    v_mfma_f32_16x16x32_bf16 v[88:91], a[116:119], v[136:139], v[88:91]
    s_waitcnt lgkmcnt(14)
    ds_read_b128 a[76:79], v195 offset:0
    v_exp_f32 v166, v166
    v_fma_f32 v168, v168, s28, -v214
    v_mfma_f32_16x16x32_bf16 v[92:95], a[116:119], v[140:143], v[92:95]
    s_waitcnt lgkmcnt(12)
    v_exp_f32 v167, v167
    v_mfma_f32_16x16x32_bf16 v[96:99], a[120:123], v[128:131], v[96:99]
    v_fma_f32 v169, v169, s28, -v214
    v_cvt_pk_bf16_f32 v162, v164, v165
    v_mfma_f32_16x16x32_bf16 v[100:103], a[120:123], v[132:135], v[100:103]
    v_exp_f32 v168, v168
    v_mfma_f32_16x16x32_bf16 a[144:147], a[128:131], v[140:143], a[144:147]
    s_waitcnt lgkmcnt(0)
    s_barrier
    v_fma_f32 v170, v170, s28, -v214
    v_exp_f32 v169, v169
    v_mfma_f32_16x16x32_bf16 v[104:107], a[120:123], v[136:139], v[104:107]
    v_fma_f32 v171, v171, s28, -v214
    v_cvt_pk_bf16_f32 v163, v166, v167
    v_mfma_f32_16x16x32_bf16 v[108:111], a[120:123], v[140:143], v[108:111]
    v_exp_f32 v170, v170
    v_mfma_f32_16x16x32_bf16 v[112:115], a[124:127], v[128:131], v[112:115]
    v_fma_f32 v172, v172, s28, -v214
    v_exp_f32 v171, v171
    v_mfma_f32_16x16x32_bf16 v[116:119], a[124:127], v[132:135], v[116:119]
    s_xor_b32 m0, s24, 0x0
    s_add_u32 s23, s20, 0x8000
    buffer_load_dwordx4 v204, s[8:11], s23 offen nt lds
    v_fma_f32 v173, v173, s28, -v214
    v_mfma_f32_16x16x32_bf16 v[120:123], a[124:127], v[136:139], v[120:123]
    v_cvt_pk_bf16_f32 v164, v168, v169
    v_exp_f32 v172, v172
    v_mfma_f32_16x16x32_bf16 v[124:127], a[124:127], v[140:143], v[124:127]
    buffer_load_dwordx4 v205, s[8:11], s23 offen offset:1024 nt lds
    s_cmp_lg_u32 s27, 0
    s_cbranch_scc1 L_rc6
L_rcr6:
    v_fma_f32 v174, v174, s28, -v214
    v_mfma_f32_16x16x32_bf16 v[128:131], a[64:67], a[0:3], 0
    v_exp_f32 v173, v173
    v_fma_f32 v175, v175, s28, -v214
    v_mfma_f32_16x16x32_bf16 v[128:131], a[68:71], a[4:7], v[128:131]
    buffer_load_dwordx4 v206, s[8:11], s23 offen offset:2048 nt lds
    v_cvt_pk_bf16_f32 v165, v170, v171
    v_exp_f32 v174, v174
    v_mfma_f32_16x16x32_bf16 v[128:131], a[72:75], a[8:11], v[128:131]
    ds_read_b128 a[80:83], v192 offset:4096
    v_fma_f32 v176, v176, s28, -v215
    v_mfma_f32_16x16x32_bf16 v[128:131], a[76:79], a[12:15], v[128:131]
    ds_read_b128 a[84:87], v193 offset:4096
    buffer_load_dwordx4 v207, s[8:11], s23 offen offset:3072 nt lds
    v_exp_f32 v175, v175
    v_fma_f32 v177, v177, s28, -v215
    v_mfma_f32_16x16x32_bf16 v[136:139], a[64:67], a[16:19], 0
    ds_read_b128 a[88:91], v194 offset:4096
    v_cvt_pk_bf16_f32 v166, v172, v173
    v_mfma_f32_16x16x32_bf16 v[136:139], a[68:71], a[20:23], v[136:139]
    ds_read_b128 a[92:95], v195 offset:4096
    v_exp_f32 v176, v176
    v_fma_f32 v178, v178, s28, -v215
    v_mfma_f32_16x16x32_bf16 v[136:139], a[72:75], a[24:27], v[136:139]
    v_exp_f32 v177, v177
    v_mfma_f32_16x16x32_bf16 v[136:139], a[76:79], a[28:31], v[136:139]
    v_fma_f32 v179, v179, s28, -v215
    v_cvt_pk_bf16_f32 v167, v174, v175
    v_mfma_f32_16x16x32_bf16 v[144:147], a[64:67], a[32:35], 0
    v_exp_f32 v178, v178
    v_fma_f32 v180, v180, s28, -v215
    v_mfma_f32_16x16x32_bf16 v[144:147], a[68:71], a[36:39], v[144:147]
    v_exp_f32 v179, v179
    v_mfma_f32_16x16x32_bf16 v[144:147], a[72:75], a[40:43], v[144:147]
    v_fma_f32 v181, v181, s28, -v215
    v_cvt_pk_bf16_f32 v168, v176, v177
    v_mfma_f32_16x16x32_bf16 v[144:147], a[76:79], a[44:47], v[144:147]
    v_exp_f32 v180, v180
    v_mfma_f32_16x16x32_bf16 v[152:155], a[64:67], a[48:51], 0
    v_fma_f32 v182, v182, s28, -v215
    v_exp_f32 v181, v181
    v_mfma_f32_16x16x32_bf16 v[152:155], a[68:71], a[52:55], v[152:155]
    v_fma_f32 v183, v183, s28, -v215
    v_mfma_f32_16x16x32_bf16 v[152:155], a[72:75], a[56:59], v[152:155]
    v_cvt_pk_bf16_f32 v169, v178, v179
    v_exp_f32 v182, v182
    v_mfma_f32_16x16x32_bf16 v[152:155], a[76:79], a[60:63], v[152:155]
    s_waitcnt lgkmcnt(3)
    v_fma_f32 v184, v184, s28, -v216
    v_exp_f32 v183, v183
    v_mfma_f32_16x16x32_bf16 v[132:135], a[80:83], a[0:3], 0
    s_waitcnt lgkmcnt(2)
    v_fma_f32 v185, v185, s28, -v216
    v_mfma_f32_16x16x32_bf16 v[132:135], a[84:87], a[4:7], v[132:135]
    s_waitcnt lgkmcnt(1)
    v_cvt_pk_bf16_f32 v170, v180, v181
    v_exp_f32 v184, v184
    v_mfma_f32_16x16x32_bf16 v[132:135], a[88:91], a[8:11], v[132:135]
    s_waitcnt lgkmcnt(0)
    v_fma_f32 v186, v186, s28, -v216
    v_mfma_f32_16x16x32_bf16 v[132:135], a[92:95], a[12:15], v[132:135]
    v_exp_f32 v185, v185
    v_fma_f32 v187, v187, s28, -v216
    v_mfma_f32_16x16x32_bf16 v[140:143], a[80:83], a[16:19], 0
    v_cvt_pk_bf16_f32 v171, v182, v183
    v_mfma_f32_16x16x32_bf16 v[140:143], a[84:87], a[20:23], v[140:143]
    v_exp_f32 v186, v186
    v_fma_f32 v188, v188, s28, -v216
    v_mfma_f32_16x16x32_bf16 v[140:143], a[88:91], a[24:27], v[140:143]
    ds_read_b64_tr_b16 a[96:97], v196 offset:57344
    v_exp_f32 v187, v187
    v_fma_f32 v189, v189, s28, -v216
    v_mfma_f32_16x16x32_bf16 v[140:143], a[92:95], a[28:31], v[140:143]
    ds_read_b64_tr_b16 a[98:99], v196 offset:61440
    v_cvt_pk_bf16_f32 v172, v184, v185
    v_mfma_f32_16x16x32_bf16 v[148:151], a[80:83], a[32:35], 0
    v_exp_f32 v188, v188
    v_fma_f32 v190, v190, s28, -v216
    v_mfma_f32_16x16x32_bf16 v[148:151], a[84:87], a[36:39], v[148:151]
    v_exp_f32 v189, v189
    v_mfma_f32_16x16x32_bf16 v[148:151], a[88:91], a[40:43], v[148:151]
    ds_read_b64_tr_b16 a[100:101], v197 offset:57344
    v_fma_f32 v191, v191, s28, -v216
    v_cvt_pk_bf16_f32 v173, v186, v187
    v_mfma_f32_16x16x32_bf16 v[148:151], a[92:95], a[44:47], v[148:151]
    ds_read_b64_tr_b16 a[102:103], v197 offset:61440
    v_exp_f32 v190, v190
    v_mfma_f32_16x16x32_bf16 v[156:159], a[80:83], a[48:51], 0
    v_exp_f32 v191, v191
    v_cvt_pk_bf16_f32 v174, v188, v189
    v_mfma_f32_16x16x32_bf16 v[156:159], a[84:87], a[52:55], v[156:159]
    v_cvt_pk_bf16_f32 v175, v190, v191
    v_mfma_f32_16x16x32_bf16 v[156:159], a[88:91], a[56:59], v[156:159]
    ds_read_b64_tr_b16 a[104:105], v198 offset:57344
    v_mfma_f32_16x16x32_bf16 v[156:159], a[92:95], a[60:63], v[156:159]
    ds_read_b64_tr_b16 a[106:107], v198 offset:61440
    v_mfma_f32_16x16x32_bf16 a[132:135], a[128:131], v[160:163], a[132:135]
    v_mfma_f32_16x16x32_bf16 a[136:139], a[128:131], v[164:167], a[136:139]
    v_mfma_f32_16x16x32_bf16 a[140:143], a[128:131], v[168:171], a[140:143]
    ds_read_b64_tr_b16 a[108:109], v199 offset:57344
    v_max3_f32 v229, v128, v129, v130
    v_max3_f32 v230, v136, v137, v138
    v_mfma_f32_16x16x32_bf16 a[144:147], a[128:131], v[172:175], a[144:147]
    s_waitcnt lgkmcnt(5)
    ds_read_b64_tr_b16 a[110:111], v199 offset:61440
    v_max3_f32 v231, v144, v145, v146
    v_max3_f32 v232, v152, v153, v154
    v_mfma_f32_16x16x32_bf16 v[0:3], a[96:99], v[160:163], v[0:3]
    v_max3_f32 v229, v229, v131, v132
    v_max3_f32 v230, v230, v139, v140
    v_mfma_f32_16x16x32_bf16 v[4:7], a[96:99], v[164:167], v[4:7]
    v_max3_f32 v231, v231, v147, v148
    v_max3_f32 v232, v232, v155, v156
    v_mfma_f32_16x16x32_bf16 v[8:11], a[96:99], v[168:171], v[8:11]
    ds_read_b64_tr_b16 a[112:113], v200 offset:57344
    v_max3_f32 v229, v229, v133, v134
    v_max3_f32 v230, v230, v141, v142
    v_mfma_f32_16x16x32_bf16 v[12:15], a[96:99], v[172:175], v[12:15]
    s_waitcnt lgkmcnt(5)
    ds_read_b64_tr_b16 a[114:115], v200 offset:61440
    v_max3_f32 v231, v231, v149, v150
    v_max3_f32 v232, v232, v157, v158
    v_mfma_f32_16x16x32_bf16 v[16:19], a[100:103], v[160:163], v[16:19]
    v_max_f32 v229, v229, v135
    v_max_f32 v230, v230, v143
    v_accvgpr_read_b32 v222, a132
    v_accvgpr_read_b32 v224, a136
    v_mfma_f32_16x16x32_bf16 v[20:23], a[100:103], v[164:167], v[20:23]
    v_max_f32 v231, v231, v151
    v_max_f32 v232, v232, v159
    v_accvgpr_read_b32 v226, a140
    v_accvgpr_read_b32 v228, a144
    v_mfma_f32_16x16x32_bf16 v[24:27], a[100:103], v[168:171], v[24:27]
    ds_read_b64_tr_b16 a[116:117], v201 offset:57344
    v_mov_b32 v233, v229
    v_mov_b32 v234, v230
    v_mov_b32 v235, v231
    v_mov_b32 v236, v232
    v_rcp_f32 v222, v222
    v_rcp_f32 v224, v224
    v_mfma_f32_16x16x32_bf16 v[28:31], a[100:103], v[172:175], v[28:31]
    s_waitcnt lgkmcnt(5)
    ds_read_b64_tr_b16 a[118:119], v201 offset:61440
    v_permlane32_swap_b32 v229, v233
    v_permlane32_swap_b32 v230, v234
    v_permlane32_swap_b32 v231, v235
    v_permlane32_swap_b32 v232, v236
    v_rcp_f32 v226, v226
    v_rcp_f32 v228, v228
    v_mfma_f32_16x16x32_bf16 v[32:35], a[104:107], v[160:163], v[32:35]
    v_max_f32 v229, v229, v233
    v_max_f32 v230, v230, v234
    v_max_f32 v231, v231, v235
    v_max_f32 v232, v232, v236
    v_xor_b32 v237, 0x0, v210
    v_mul_f32 v0, v0, v222
    v_mul_f32 v1, v1, v222
    v_mfma_f32_16x16x32_bf16 v[36:39], a[104:107], v[164:167], v[36:39]
    v_mov_b32 v233, v229
    v_mov_b32 v234, v230
    v_mov_b32 v235, v231
    v_mov_b32 v236, v232
    v_mul_f32 v2, v2, v222
    v_mul_f32 v3, v3, v222
    v_cvt_pk_bf16_f32 v0, v0, v1
    v_mfma_f32_16x16x32_bf16 v[40:43], a[104:107], v[168:171], v[40:43]
    ds_read_b64_tr_b16 a[120:121], v202 offset:57344
    v_permlane16_swap_b32 v229, v233
    v_permlane16_swap_b32 v230, v234
    v_permlane16_swap_b32 v231, v235
    v_permlane16_swap_b32 v232, v236
    v_cvt_pk_bf16_f32 v1, v2, v3
    v_mul_f32 v4, v4, v224
    v_mfma_f32_16x16x32_bf16 v[44:47], a[104:107], v[172:175], v[44:47]
    s_waitcnt lgkmcnt(5)
    ds_read_b64_tr_b16 a[122:123], v202 offset:61440
    ds_write_b64 v237, v[0:1] offset:0
    v_max_f32 v229, v229, v233
    v_max_f32 v230, v230, v234
    v_max_f32 v231, v231, v235
    v_max_f32 v232, v232, v236
    v_mul_f32 v5, v5, v224
    v_mul_f32 v6, v6, v224
    v_mul_f32 v7, v7, v224
    v_mfma_f32_16x16x32_bf16 v[48:51], a[108:111], v[160:163], v[48:51]
    v_mul_f32 v213, s28, v229
    v_mul_f32 v214, s28, v230
    v_mul_f32 v215, s28, v231
    v_mul_f32 v216, s28, v232
    v_cvt_pk_bf16_f32 v4, v4, v5
    v_cvt_pk_bf16_f32 v5, v6, v7
    v_mfma_f32_16x16x32_bf16 v[52:55], a[108:111], v[164:167], v[52:55]
    v_add_f32 v217, 0x427af233, v229
    v_add_f32 v218, 0x427af233, v230
    v_add_f32 v219, 0x427af233, v231
    v_add_f32 v220, 0x427af233, v232
    v_mul_f32 v8, v8, v226
    v_mul_f32 v9, v9, v226
    v_mfma_f32_16x16x32_bf16 v[56:59], a[108:111], v[168:171], v[56:59]
    ds_read_b128 a[64:67], v192 offset:8192
    ds_read_b64_tr_b16 a[124:125], v203 offset:57344
    ds_write_b64 v237, v[4:5] offset:2048
    v_fma_f32 v128, v128, s28, -v213
    v_fma_f32 v129, v129, s28, -v213
    v_mul_f32 v10, v10, v226
    v_mul_f32 v11, v11, v226
    v_cvt_pk_bf16_f32 v8, v8, v9
    v_mfma_f32_16x16x32_bf16 v[60:63], a[108:111], v[172:175], v[60:63]
    s_waitcnt lgkmcnt(8)
    ds_read_b128 a[68:71], v193 offset:8192
    ds_read_b64_tr_b16 a[126:127], v203 offset:61440
    v_exp_f32 v128, v128
    v_fma_f32 v130, v130, s28, -v213
    v_cvt_pk_bf16_f32 v9, v10, v11
    v_mul_f32 v12, v12, v228
    v_mfma_f32_16x16x32_bf16 v[64:67], a[112:115], v[160:163], v[64:67]
    ds_read_b128 a[72:75], v194 offset:8192
    ds_write_b64 v237, v[8:9] offset:4096
    v_exp_f32 v129, v129
    v_mul_f32 v13, v13, v228
    v_mul_f32 v14, v14, v228
    v_mfma_f32_16x16x32_bf16 v[68:71], a[112:115], v[164:167], v[68:71]
    ds_read_b128 a[76:79], v195 offset:8192
    v_fma_f32 v131, v131, s28, -v213
    v_exp_f32 v130, v130
    v_mul_f32 v15, v15, v228
    v_cvt_pk_bf16_f32 v12, v12, v13
    v_cvt_pk_bf16_f32 v13, v14, v15
    v_mfma_f32_16x16x32_bf16 v[72:75], a[112:115], v[168:171], v[72:75]
    v_fma_f32 v132, v132, s28, -v213
    v_exp_f32 v131, v131
    v_xor_b32 v238, 0x20, v210
    v_mul_f32 v16, v16, v222
    v_mfma_f32_16x16x32_bf16 v[76:79], a[112:115], v[172:175], v[76:79]
    s_waitcnt lgkmcnt(11)
    ds_write_b64 v237, v[12:13] offset:6144
    v_fma_f32 v133, v133, s28, -v213
    v_mul_f32 v17, v17, v222
    v_mul_f32 v18, v18, v222
    v_mul_f32 v19, v19, v222
    v_mfma_f32_16x16x32_bf16 v[80:83], a[116:119], v[160:163], v[80:83]
    v_cvt_pk_bf16_f32 v128, v128, v129
    v_exp_f32 v132, v132
    v_cvt_pk_bf16_f32 v16, v16, v17
    v_cvt_pk_bf16_f32 v17, v18, v19
    v_mfma_f32_16x16x32_bf16 v[84:87], a[116:119], v[164:167], v[84:87]
    v_fma_f32 v134, v134, s28, -v213
    v_exp_f32 v133, v133
    v_mul_f32 v20, v20, v224
    v_mul_f32 v21, v21, v224
    v_mfma_f32_16x16x32_bf16 v[88:91], a[116:119], v[168:171], v[88:91]
    s_waitcnt vmcnt(8) lgkmcnt(0)
    s_barrier
    ds_write_b64 v238, v[16:17] offset:0
    v_fma_f32 v135, v135, s28, -v213
    v_mul_f32 v22, v22, v224
    v_mul_f32 v23, v23, v224
    v_cvt_pk_bf16_f32 v20, v20, v21
    v_mfma_f32_16x16x32_bf16 v[92:95], a[116:119], v[172:175], v[92:95]
    v_cvt_pk_bf16_f32 v129, v130, v131
    v_exp_f32 v134, v134
    v_cvt_pk_bf16_f32 v21, v22, v23
    v_mul_f32 v24, v24, v226
    v_mfma_f32_16x16x32_bf16 v[96:99], a[120:123], v[160:163], v[96:99]
    ds_write_b64 v238, v[20:21] offset:2048
    v_fma_f32 v136, v136, s28, -v214
    v_exp_f32 v135, v135
    v_mul_f32 v25, v25, v226
    v_mul_f32 v26, v26, v226
    v_mfma_f32_16x16x32_bf16 v[100:103], a[120:123], v[164:167], v[100:103]
    v_fma_f32 v137, v137, s28, -v214
    v_mul_f32 v27, v27, v226
    v_cvt_pk_bf16_f32 v24, v24, v25
    v_cvt_pk_bf16_f32 v25, v26, v27
    v_mfma_f32_16x16x32_bf16 v[104:107], a[120:123], v[168:171], v[104:107]
    s_xor_b32 m0, s24, 0x1c000
    s_add_u32 s23, s20, 0x4000
    buffer_load_dwordx4 v208, s[12:15], s23 offen nt lds
    v_cvt_pk_bf16_f32 v130, v132, v133
    v_exp_f32 v136, v136
    v_mul_f32 v28, v28, v228
    v_mul_f32 v29, v29, v228
    v_mfma_f32_16x16x32_bf16 v[108:111], a[120:123], v[172:175], v[108:111]
    ds_write_b64 v238, v[24:25] offset:4096
    v_fma_f32 v138, v138, s28, -v214
    v_exp_f32 v137, v137
    v_mul_f32 v30, v30, v228
    v_mul_f32 v31, v31, v228
    v_cvt_pk_bf16_f32 v28, v28, v29
    v_mfma_f32_16x16x32_bf16 v[112:115], a[124:127], v[160:163], v[112:115]
    buffer_load_dwordx4 v209, s[12:15], s23 offen offset:1024 nt lds
    v_fma_f32 v139, v139, s28, -v214
    v_cvt_pk_bf16_f32 v29, v30, v31
    v_mfma_f32_16x16x32_bf16 v[116:119], a[124:127], v[164:167], v[116:119]
    ds_write_b64 v238, v[28:29] offset:6144
    v_cvt_pk_bf16_f32 v131, v134, v135
    v_exp_f32 v138, v138
    v_xor_b32 v237, 0x40, v210
    v_mul_f32 v32, v32, v222
    v_mul_f32 v33, v33, v222
    v_mfma_f32_16x16x32_bf16 v[120:123], a[124:127], v[168:171], v[120:123]
    buffer_load_dwordx4 v208, s[12:15], s23 offen offset:2048 nt lds
    v_fma_f32 v140, v140, s28, -v214
    v_exp_f32 v139, v139
    v_mul_f32 v34, v34, v222
    v_mul_f32 v35, v35, v222
    v_cvt_pk_bf16_f32 v32, v32, v33
    v_mfma_f32_16x16x32_bf16 v[124:127], a[124:127], v[172:175], v[124:127]
    v_fma_f32 v141, v141, s28, -v214
    v_cvt_pk_bf16_f32 v33, v34, v35
    v_mul_f32 v36, v36, v224
    v_mfma_f32_16x16x32_bf16 v[160:163], a[64:67], a[0:3], 0
    ds_write_b64 v237, v[32:33] offset:0
    buffer_load_dwordx4 v209, s[12:15], s23 offen offset:3072 nt lds
    v_cvt_pk_bf16_f32 v132, v136, v137
    v_exp_f32 v140, v140
    v_mul_f32 v37, v37, v224
    v_mul_f32 v38, v38, v224
    v_mul_f32 v39, v39, v224
    v_mfma_f32_16x16x32_bf16 v[160:163], a[68:71], a[4:7], v[160:163]
    v_fma_f32 v142, v142, s28, -v214
    v_exp_f32 v141, v141
    v_cvt_pk_bf16_f32 v36, v36, v37
    v_cvt_pk_bf16_f32 v37, v38, v39
    v_mfma_f32_16x16x32_bf16 v[160:163], a[72:75], a[8:11], v[160:163]
    ds_read_b128 a[80:83], v192 offset:12288
    v_fma_f32 v143, v143, s28, -v214
    v_mul_f32 v40, v40, v226
    v_mul_f32 v41, v41, v226
    v_mfma_f32_16x16x32_bf16 v[160:163], a[76:79], a[12:15], v[160:163]
    ds_read_b128 a[84:87], v193 offset:12288
    ds_write_b64 v237, v[36:37] offset:2048
    v_cvt_pk_bf16_f32 v133, v138, v139
    v_exp_f32 v142, v142
    v_mul_f32 v42, v42, v226
    v_mul_f32 v43, v43, v226
    v_cvt_pk_bf16_f32 v40, v40, v41
    v_mfma_f32_16x16x32_bf16 v[168:171], a[64:67], a[16:19], 0
    ds_read_b128 a[88:91], v194 offset:12288
    v_fma_f32 v144, v144, s28, -v215
    v_exp_f32 v143, v143
    v_cvt_pk_bf16_f32 v41, v42, v43
    v_mul_f32 v44, v44, v228
    v_mfma_f32_16x16x32_bf16 v[168:171], a[68:71], a[20:23], v[168:171]
    ds_read_b128 a[92:95], v195 offset:12288
    ds_write_b64 v237, v[40:41] offset:4096
    v_fma_f32 v145, v145, s28, -v215
    v_mul_f32 v45, v45, v228
    v_mul_f32 v46, v46, v228
    v_mfma_f32_16x16x32_bf16 v[168:171], a[72:75], a[24:27], v[168:171]
    v_cvt_pk_bf16_f32 v134, v140, v141
    v_exp_f32 v144, v144
    v_mul_f32 v47, v47, v228
    v_cvt_pk_bf16_f32 v44, v44, v45
    v_cvt_pk_bf16_f32 v45, v46, v47
    v_mfma_f32_16x16x32_bf16 v[168:171], a[76:79], a[28:31], v[168:171]
    v_fma_f32 v146, v146, s28, -v215
    v_exp_f32 v145, v145
    v_xor_b32 v238, 0x60, v210
    v_mul_f32 v48, v48, v222
    v_mfma_f32_16x16x32_bf16 v[176:179], a[64:67], a[32:35], 0
    ds_write_b64 v237, v[44:45] offset:6144
    v_fma_f32 v147, v147, s28, -v215
    v_mul_f32 v49, v49, v222
    v_mul_f32 v50, v50, v222
    v_mul_f32 v51, v51, v222
    v_mfma_f32_16x16x32_bf16 v[176:179], a[68:71], a[36:39], v[176:179]
    v_cvt_pk_bf16_f32 v135, v142, v143
    v_exp_f32 v146, v146
    v_cvt_pk_bf16_f32 v48, v48, v49
    v_cvt_pk_bf16_f32 v49, v50, v51
    v_mfma_f32_16x16x32_bf16 v[176:179], a[72:75], a[40:43], v[176:179]
    v_fma_f32 v148, v148, s28, -v215
    v_exp_f32 v147, v147
    v_mul_f32 v52, v52, v224
    v_mul_f32 v53, v53, v224
    v_mfma_f32_16x16x32_bf16 v[176:179], a[76:79], a[44:47], v[176:179]
    ds_write_b64 v238, v[48:49] offset:0
    v_fma_f32 v149, v149, s28, -v215
    v_mul_f32 v54, v54, v224
    v_mul_f32 v55, v55, v224
    v_cvt_pk_bf16_f32 v52, v52, v53
    v_mfma_f32_16x16x32_bf16 v[184:187], a[64:67], a[48:51], 0
    v_cvt_pk_bf16_f32 v136, v144, v145
    v_exp_f32 v148, v148
    v_cvt_pk_bf16_f32 v53, v54, v55
    v_mul_f32 v56, v56, v226
    v_mfma_f32_16x16x32_bf16 v[184:187], a[68:71], a[52:55], v[184:187]
    ds_write_b64 v238, v[52:53] offset:2048
    v_fma_f32 v150, v150, s28, -v215
    v_exp_f32 v149, v149
    v_mul_f32 v57, v57, v226
    v_mul_f32 v58, v58, v226
    v_mfma_f32_16x16x32_bf16 v[184:187], a[72:75], a[56:59], v[184:187]
    s_xor_b32 m0, s24, 0x4000
    s_add_u32 s23, s20, 0x8000
    buffer_load_dwordx4 v208, s[12:15], s23 offen nt lds
    v_fma_f32 v151, v151, s28, -v215
    v_mul_f32 v59, v59, v226
    v_cvt_pk_bf16_f32 v56, v56, v57
    v_cvt_pk_bf16_f32 v57, v58, v59
    v_mfma_f32_16x16x32_bf16 v[184:187], a[76:79], a[60:63], v[184:187]
    s_waitcnt lgkmcnt(8)
    v_cvt_pk_bf16_f32 v137, v146, v147
    v_exp_f32 v150, v150
    v_mul_f32 v60, v60, v228
    v_mul_f32 v61, v61, v228
    v_mfma_f32_16x16x32_bf16 v[164:167], a[80:83], a[0:3], 0
    s_waitcnt lgkmcnt(7)
    ds_write_b64 v238, v[56:57] offset:4096
    buffer_load_dwordx4 v209, s[12:15], s23 offen offset:1024 nt lds
    v_fma_f32 v152, v152, s28, -v216
    v_exp_f32 v151, v151
    v_mul_f32 v62, v62, v228
    v_mul_f32 v63, v63, v228
    v_cvt_pk_bf16_f32 v60, v60, v61
    v_mfma_f32_16x16x32_bf16 v[164:167], a[84:87], a[4:7], v[164:167]
    s_waitcnt lgkmcnt(6)
    v_fma_f32 v153, v153, s28, -v216
    v_cvt_pk_bf16_f32 v61, v62, v63
    v_mfma_f32_16x16x32_bf16 v[164:167], a[88:91], a[8:11], v[164:167]
    s_waitcnt lgkmcnt(5)
    ds_read_b64_tr_b16 a[96:97], v196 offset:16384
    ds_write_b64 v238, v[60:61] offset:6144
    buffer_load_dwordx4 v208, s[12:15], s23 offen offset:2048 nt lds
    v_cvt_pk_bf16_f32 v138, v148, v149
    v_exp_f32 v152, v152
    v_mfma_f32_16x16x32_bf16 v[164:167], a[92:95], a[12:15], v[164:167]
    ds_read_b64_tr_b16 a[98:99], v196 offset:20480
    ds_read_b128 a[148:151], v211 offset:0
    ds_read_b128 a[152:155], v211 offset:1024
    v_fma_f32 v154, v154, s28, -v216
    v_exp_f32 v153, v153
    v_mfma_f32_16x16x32_bf16 v[172:175], a[80:83], a[16:19], 0
    ds_read_b128 a[156:159], v211 offset:2048
    ds_read_b128 a[160:163], v211 offset:3072
    buffer_load_dwordx4 v209, s[12:15], s23 offen offset:3072 nt lds
    v_fma_f32 v155, v155, s28, -v216
    v_xor_b32 v237, 0x0, v210
    v_mul_f32 v64, v64, v222
    v_mul_f32 v65, v65, v222
    v_mfma_f32_16x16x32_bf16 v[172:175], a[84:87], a[20:23], v[172:175]
    ds_read_b128 a[164:167], v211 offset:4096
    ds_read_b128 a[168:171], v211 offset:5120
    v_cvt_pk_bf16_f32 v139, v150, v151
    v_exp_f32 v154, v154
    v_mul_f32 v66, v66, v222
    v_mul_f32 v67, v67, v222
    v_cvt_pk_bf16_f32 v64, v64, v65
    v_mfma_f32_16x16x32_bf16 v[172:175], a[88:91], a[24:27], v[172:175]
    ds_read_b128 a[172:175], v211 offset:6144
    s_waitcnt lgkmcnt(14)
    ds_read_b128 a[176:179], v211 offset:7168
    v_fma_f32 v156, v156, s28, -v216
    v_exp_f32 v155, v155
    v_cvt_pk_bf16_f32 v65, v66, v67
    v_mfma_f32_16x16x32_bf16 v[172:175], a[92:95], a[28:31], v[172:175]
    s_waitcnt lgkmcnt(14)
    ds_read_b64_tr_b16 a[100:101], v197 offset:16384
    s_waitcnt lgkmcnt(14)
    ds_write_b64 v237, v[64:65] offset:0
    v_fma_f32 v157, v157, s28, -v216
    v_mul_f32 v68, v68, v224
    v_mul_f32 v69, v69, v224
    v_mul_f32 v70, v70, v224
    v_mfma_f32_16x16x32_bf16 v[180:183], a[80:83], a[32:35], 0
    s_waitcnt lgkmcnt(14)
    ds_read_b64_tr_b16 a[102:103], v197 offset:20480
    v_cvt_pk_bf16_f32 v140, v152, v153
    v_exp_f32 v156, v156
    v_mul_f32 v71, v71, v224
    v_cvt_pk_bf16_f32 v68, v68, v69
    v_cvt_pk_bf16_f32 v69, v70, v71
    v_mfma_f32_16x16x32_bf16 v[180:183], a[84:87], a[36:39], v[180:183]
    v_fma_f32 v158, v158, s28, -v216
    v_exp_f32 v157, v157
    v_mul_f32 v72, v72, v226
    v_mfma_f32_16x16x32_bf16 v[180:183], a[88:91], a[40:43], v[180:183]
    s_waitcnt lgkmcnt(14)
    ds_write_b64 v237, v[68:69] offset:2048
    v_fma_f32 v159, v159, s28, -v216
    v_mul_f32 v73, v73, v226
    v_mul_f32 v74, v74, v226
    v_mul_f32 v75, v75, v226
    v_mfma_f32_16x16x32_bf16 v[180:183], a[92:95], a[44:47], v[180:183]
    s_waitcnt lgkmcnt(14)
    ds_read_b64_tr_b16 a[104:105], v198 offset:16384
    v_cvt_pk_bf16_f32 v141, v154, v155
    v_exp_f32 v158, v158
    v_cvt_pk_bf16_f32 v72, v72, v73
    v_cvt_pk_bf16_f32 v73, v74, v75
    v_mfma_f32_16x16x32_bf16 v[188:191], a[80:83], a[48:51], 0
    s_waitcnt lgkmcnt(14)
    ds_read_b64_tr_b16 a[106:107], v198 offset:20480
    s_waitcnt lgkmcnt(14)
    ds_write_b64 v237, v[72:73] offset:4096
    v_exp_f32 v159, v159
    v_cvt_pk_bf16_f32 v142, v156, v157
    v_mul_f32 v76, v76, v228
    v_mul_f32 v77, v77, v228
    v_mfma_f32_16x16x32_bf16 v[188:191], a[84:87], a[52:55], v[188:191]
    v_cvt_pk_bf16_f32 v143, v158, v159
    v_mul_f32 v78, v78, v228
    v_mul_f32 v79, v79, v228
    v_cvt_pk_bf16_f32 v76, v76, v77
    v_mfma_f32_16x16x32_bf16 v[188:191], a[88:91], a[56:59], v[188:191]
    s_waitcnt lgkmcnt(14)
    buffer_store_dwordx4 a[148:151], v212, s[16:19], s22 offen offset:0 sc1
    v_cvt_pk_bf16_f32 v77, v78, v79
    v_mfma_f32_16x16x32_bf16 v[188:191], a[92:95], a[60:63], v[188:191]
    ds_write_b64 v237, v[76:77] offset:6144
    v_xor_b32 v238, 0x20, v210
    v_mul_f32 v80, v80, v222
    v_mul_f32 v81, v81, v222
    v_mfma_f32_16x16x32_bf16 v[0:3], a[96:99], v[128:131], 0
    s_waitcnt lgkmcnt(14)
    ds_read_b64_tr_b16 a[108:109], v199 offset:16384
    v_mul_f32 v82, v82, v222
    v_mul_f32 v83, v83, v222
    v_cvt_pk_bf16_f32 v80, v80, v81
    v_mfma_f32_16x16x32_bf16 v[4:7], a[96:99], v[132:135], 0
    s_waitcnt lgkmcnt(14)
    ds_read_b64_tr_b16 a[110:111], v199 offset:20480
    v_cvt_pk_bf16_f32 v81, v82, v83
    v_mfma_f32_16x16x32_bf16 a[132:135], a[128:131], v[128:131], 0
    s_waitcnt lgkmcnt(14)
    ds_write_b64 v238, v[80:81] offset:0
    v_max3_f32 v229, v160, v161, v162
    v_max3_f32 v230, v168, v169, v170
    v_mul_f32 v84, v84, v224
    v_mul_f32 v85, v85, v224
    v_mul_f32 v86, v86, v224
    v_mfma_f32_16x16x32_bf16 v[8:11], a[96:99], v[136:139], 0
    v_max3_f32 v231, v176, v177, v178
    v_max3_f32 v232, v184, v185, v186
    v_mul_f32 v87, v87, v224
    v_cvt_pk_bf16_f32 v84, v84, v85
    v_cvt_pk_bf16_f32 v85, v86, v87
    v_mfma_f32_16x16x32_bf16 v[12:15], a[96:99], v[140:143], 0
    s_waitcnt lgkmcnt(8)
    ds_read_b64_tr_b16 a[112:113], v200 offset:16384
    v_max3_f32 v229, v229, v163, v164
    v_max3_f32 v230, v230, v171, v172
    v_mul_f32 v88, v88, v226
    v_mfma_f32_16x16x32_bf16 v[16:19], a[100:103], v[128:131], 0
    ds_read_b64_tr_b16 a[114:115], v200 offset:20480
    ds_write_b64 v238, v[84:85] offset:2048
    v_max3_f32 v231, v231, v179, v180
    v_max3_f32 v232, v232, v187, v188
    v_mul_f32 v89, v89, v226
    v_mul_f32 v90, v90, v226
    v_mul_f32 v91, v91, v226
    v_mfma_f32_16x16x32_bf16 v[20:23], a[100:103], v[132:135], 0
    v_max3_f32 v229, v229, v165, v166
    v_max3_f32 v230, v230, v173, v174
    v_cvt_pk_bf16_f32 v88, v88, v89
    v_cvt_pk_bf16_f32 v89, v90, v91
    v_mfma_f32_16x16x32_bf16 v[24:27], a[100:103], v[136:139], 0
    ds_write_b64 v238, v[88:89] offset:4096
    v_max3_f32 v231, v231, v181, v182
    v_max3_f32 v232, v232, v189, v190
    v_mul_f32 v92, v92, v228
    v_mul_f32 v93, v93, v228
    v_mfma_f32_16x16x32_bf16 v[28:31], a[100:103], v[140:143], 0
    s_waitcnt lgkmcnt(9)
    v_max_f32 v229, v229, v167
    v_max_f32 v230, v230, v175
    v_mul_f32 v94, v94, v228
    v_mul_f32 v95, v95, v228
    v_cvt_pk_bf16_f32 v92, v92, v93
    v_mfma_f32_16x16x32_bf16 v[32:35], a[104:107], v[128:131], 0
    ds_read_b64_tr_b16 a[116:117], v201 offset:16384
    v_max_f32 v231, v231, v183
    v_max_f32 v232, v232, v191
    v_cvt_pk_bf16_f32 v93, v94, v95
    v_mfma_f32_16x16x32_bf16 v[36:39], a[104:107], v[132:135], 0
    ds_read_b64_tr_b16 a[118:119], v201 offset:20480
    ds_write_b64 v238, v[92:93] offset:6144
    v_xor_b32 v237, 0x40, v210
    v_mul_f32 v96, v96, v222
    v_mul_f32 v97, v97, v222
    v_mfma_f32_16x16x32_bf16 a[136:139], a[128:131], v[132:135], 0
    v_cmp_gt_f32 s[32:33], v229, v217
    v_cmp_gt_f32 s[34:35], v230, v218
    v_mul_f32 v98, v98, v222
    v_mul_f32 v99, v99, v222
    v_cvt_pk_bf16_f32 v96, v96, v97
    v_mfma_f32_16x16x32_bf16 v[40:43], a[104:107], v[136:139], 0
    v_cmp_gt_f32 s[36:37], v231, v219
    v_cmp_gt_f32 s[38:39], v232, v220
    v_cvt_pk_bf16_f32 v97, v98, v99
    v_mfma_f32_16x16x32_bf16 v[44:47], a[104:107], v[140:143], 0
    s_waitcnt lgkmcnt(8)
    ds_read_b64_tr_b16 a[120:121], v202 offset:16384
    ds_write_b64 v237, v[96:97] offset:0
    s_or_b64 s[32:33], s[32:33], s[34:35]
    s_or_b64 s[36:37], s[36:37], s[38:39]
    v_mul_f32 v100, v100, v224
    v_mul_f32 v101, v101, v224
    v_mul_f32 v102, v102, v224
    v_mfma_f32_16x16x32_bf16 v[48:51], a[108:111], v[128:131], 0
    ds_read_b64_tr_b16 a[122:123], v202 offset:20480
    s_or_b64 s[32:33], s[32:33], s[36:37]
    s_cbranch_scc1 L_rb0
L_rbr0:
    v_mul_f32 v103, v103, v224
    v_cvt_pk_bf16_f32 v100, v100, v101
    v_cvt_pk_bf16_f32 v101, v102, v103
    v_mfma_f32_16x16x32_bf16 v[52:55], a[108:111], v[132:135], 0
    v_fma_f32 v160, v160, s28, -v213
    v_fma_f32 v161, v161, s28, -v213
    v_mul_f32 v104, v104, v226
    v_mfma_f32_16x16x32_bf16 v[56:59], a[108:111], v[136:139], 0
    ds_write_b64 v237, v[100:101] offset:2048
    v_exp_f32 v160, v160
    v_fma_f32 v162, v162, s28, -v213
    v_mul_f32 v105, v105, v226
    v_mul_f32 v106, v106, v226
    v_mul_f32 v107, v107, v226
    v_mfma_f32_16x16x32_bf16 v[60:63], a[108:111], v[140:143], 0
    s_waitcnt lgkmcnt(9)
    v_exp_f32 v161, v161
    v_cvt_pk_bf16_f32 v104, v104, v105
    v_cvt_pk_bf16_f32 v105, v106, v107
    v_mfma_f32_16x16x32_bf16 v[64:67], a[112:115], v[128:131], 0
    ds_read_b64_tr_b16 a[124:125], v203 offset:16384
    ds_write_b64 v237, v[104:105] offset:4096
    v_fma_f32 v163, v163, s28, -v213
    v_exp_f32 v162, v162
    v_mul_f32 v108, v108, v228
    v_mul_f32 v109, v109, v228
    v_mfma_f32_16x16x32_bf16 v[68:71], a[112:115], v[132:135], 0
    ds_read_b64_tr_b16 a[126:127], v203 offset:20480
    v_fma_f32 v164, v164, s28, -v213
    v_mul_f32 v110, v110, v228
    v_mul_f32 v111, v111, v228
    v_cvt_pk_bf16_f32 v108, v108, v109
    v_mfma_f32_16x16x32_bf16 a[140:143], a[128:131], v[136:139], 0
    v_exp_f32 v163, v163
    v_fma_f32 v165, v165, s28, -v213
    v_cvt_pk_bf16_f32 v109, v110, v111
    v_mfma_f32_16x16x32_bf16 v[72:75], a[112:115], v[136:139], 0
    ds_write_b64 v237, v[108:109] offset:6144
    v_cvt_pk_bf16_f32 v160, v160, v161
    v_xor_b32 v238, 0x60, v210
    v_mul_f32 v112, v112, v222
    v_mul_f32 v113, v113, v222
    v_mfma_f32_16x16x32_bf16 v[76:79], a[112:115], v[140:143], 0
    s_waitcnt lgkmcnt(9)
    buffer_store_dwordx4 a[152:155], v212, s[16:19], s22 offen offset:2048 sc1
    v_exp_f32 v164, v164
    v_fma_f32 v166, v166, s28, -v213
    v_mul_f32 v114, v114, v222
    v_mul_f32 v115, v115, v222
    v_cvt_pk_bf16_f32 v112, v112, v113
    v_mfma_f32_16x16x32_bf16 v[80:83], a[116:119], v[128:131], 0
    v_exp_f32 v165, v165
    v_fma_f32 v167, v167, s28, -v213
    v_cvt_pk_bf16_f32 v113, v114, v115
    v_mfma_f32_16x16x32_bf16 v[84:87], a[116:119], v[132:135], 0
    ds_write_b64 v238, v[112:113] offset:0
    v_cvt_pk_bf16_f32 v161, v162, v163
    v_mul_f32 v116, v116, v224
    v_mul_f32 v117, v117, v224
    v_mul_f32 v118, v118, v224
    v_mfma_f32_16x16x32_bf16 v[88:91], a[116:119], v[136:139], 0
    v_exp_f32 v166, v166
    v_fma_f32 v168, v168, s28, -v214
    v_mul_f32 v119, v119, v224
    v_cvt_pk_bf16_f32 v116, v116, v117
    v_cvt_pk_bf16_f32 v117, v118, v119
    v_mfma_f32_16x16x32_bf16 v[92:95], a[116:119], v[140:143], 0
    s_waitcnt vmcnt(14) lgkmcnt(0)
    s_barrier
    ds_read_b128 a[64:67], v192 offset:32768
    v_exp_f32 v167, v167
    v_mul_f32 v120, v120, v226
    v_mfma_f32_16x16x32_bf16 v[96:99], a[120:123], v[128:131], 0
    ds_read_b128 a[68:71], v193 offset:32768
    ds_write_b64 v238, v[116:117] offset:2048
    v_fma_f32 v169, v169, s28, -v214
    v_cvt_pk_bf16_f32 v162, v164, v165
    v_mul_f32 v121, v121, v226
    v_mul_f32 v122, v122, v226
    v_mul_f32 v123, v123, v226
    v_mfma_f32_16x16x32_bf16 v[100:103], a[120:123], v[132:135], 0
    ds_read_b128 a[72:75], v194 offset:32768
    v_exp_f32 v168, v168
    v_cvt_pk_bf16_f32 v120, v120, v121
    v_cvt_pk_bf16_f32 v121, v122, v123
    v_mfma_f32_16x16x32_bf16 a[144:147], a[128:131], v[140:143], 0
    ds_read_b128 a[76:79], v195 offset:32768
    ds_write_b64 v238, v[120:121] offset:4096
    v_fma_f32 v170, v170, s28, -v214
    v_exp_f32 v169, v169
    v_mul_f32 v124, v124, v228
    v_mul_f32 v125, v125, v228
    v_mfma_f32_16x16x32_bf16 v[104:107], a[120:123], v[136:139], 0
    s_xor_b32 m0, s24, 0x8000
    s_add_u32 s23, s20, 0xc000
    buffer_load_dwordx4 v204, s[8:11], s23 offen nt lds
    v_fma_f32 v171, v171, s28, -v214
    v_cvt_pk_bf16_f32 v163, v166, v167
    v_mul_f32 v126, v126, v228
    v_mul_f32 v127, v127, v228
    v_cvt_pk_bf16_f32 v124, v124, v125
    v_mfma_f32_16x16x32_bf16 v[108:111], a[120:123], v[140:143], 0
    v_exp_f32 v170, v170
    v_cvt_pk_bf16_f32 v125, v126, v127
    v_mfma_f32_16x16x32_bf16 v[112:115], a[124:127], v[128:131], 0
    ds_write_b64 v238, v[124:125] offset:6144
    buffer_load_dwordx4 v205, s[8:11], s23 offen offset:1024 nt lds
    v_fma_f32 v172, v172, s28, -v214
    v_exp_f32 v171, v171
    v_mfma_f32_16x16x32_bf16 v[116:119], a[124:127], v[132:135], 0
    v_fma_f32 v173, v173, s28, -v214
    v_mfma_f32_16x16x32_bf16 v[120:123], a[124:127], v[136:139], 0
    ds_read_b128 a[180:183], v211 offset:0
    ds_read_b128 a[184:187], v211 offset:1024
    buffer_load_dwordx4 v206, s[8:11], s23 offen offset:2048 nt lds
    v_cvt_pk_bf16_f32 v164, v168, v169
    v_exp_f32 v172, v172
    v_mfma_f32_16x16x32_bf16 v[124:127], a[124:127], v[140:143], 0
    ds_read_b128 a[188:191], v211 offset:2048
    ds_read_b128 a[192:195], v211 offset:3072
    s_cmp_lg_u32 s27, 0
    s_cbranch_scc1 L_rc0
L_rcr0:
    v_fma_f32 v174, v174, s28, -v214
    s_waitcnt lgkmcnt(10)
    v_mfma_f32_16x16x32_bf16 v[128:131], a[64:67], a[0:3], 0
    s_waitcnt lgkmcnt(9)
    ds_read_b128 a[196:199], v211 offset:4096
    ds_read_b128 a[200:203], v211 offset:5120
    buffer_load_dwordx4 v207, s[8:11], s23 offen offset:3072 nt lds
    v_exp_f32 v173, v173
    v_fma_f32 v175, v175, s28, -v214
    v_mfma_f32_16x16x32_bf16 v[128:131], a[68:71], a[4:7], v[128:131]
    s_waitcnt lgkmcnt(9)
    ds_read_b128 a[204:207], v211 offset:6144
    ds_read_b128 a[208:211], v211 offset:7168
    v_cvt_pk_bf16_f32 v165, v170, v171
    v_exp_f32 v174, v174
    v_mfma_f32_16x16x32_bf16 v[128:131], a[72:75], a[8:11], v[128:131]
    s_waitcnt lgkmcnt(10)
    ds_read_b128 a[80:83], v192 offset:36864
    v_fma_f32 v176, v176, s28, -v215
    v_mfma_f32_16x16x32_bf16 v[128:131], a[76:79], a[12:15], v[128:131]
    ds_read_b128 a[84:87], v193 offset:36864
    v_exp_f32 v175, v175
    v_fma_f32 v177, v177, s28, -v215
    v_mfma_f32_16x16x32_bf16 v[136:139], a[64:67], a[16:19], 0
    ds_read_b128 a[88:91], v194 offset:36864
    v_cvt_pk_bf16_f32 v166, v172, v173
    v_mfma_f32_16x16x32_bf16 v[136:139], a[68:71], a[20:23], v[136:139]
    ds_read_b128 a[92:95], v195 offset:36864
    v_exp_f32 v176, v176
    v_fma_f32 v178, v178, s28, -v215
    v_mfma_f32_16x16x32_bf16 v[136:139], a[72:75], a[24:27], v[136:139]
    v_exp_f32 v177, v177
    v_mfma_f32_16x16x32_bf16 v[136:139], a[76:79], a[28:31], v[136:139]
    v_fma_f32 v179, v179, s28, -v215
    v_cvt_pk_bf16_f32 v167, v174, v175
    v_mfma_f32_16x16x32_bf16 v[144:147], a[64:67], a[32:35], 0
    v_exp_f32 v178, v178
    v_fma_f32 v180, v180, s28, -v215
    v_mfma_f32_16x16x32_bf16 v[144:147], a[68:71], a[36:39], v[144:147]
    v_exp_f32 v179, v179
    v_mfma_f32_16x16x32_bf16 v[144:147], a[72:75], a[40:43], v[144:147]
    buffer_store_dwordx4 a[156:159], v212, s[16:19], s29 offen offset:0 sc1
    v_fma_f32 v181, v181, s28, -v215
    v_cvt_pk_bf16_f32 v168, v176, v177
    v_mfma_f32_16x16x32_bf16 v[144:147], a[76:79], a[44:47], v[144:147]
    v_exp_f32 v180, v180
    v_mfma_f32_16x16x32_bf16 v[152:155], a[64:67], a[48:51], 0
    v_fma_f32 v182, v182, s28, -v215
    v_exp_f32 v181, v181
    v_mfma_f32_16x16x32_bf16 v[152:155], a[68:71], a[52:55], v[152:155]
    v_fma_f32 v183, v183, s28, -v215
    v_mfma_f32_16x16x32_bf16 v[152:155], a[72:75], a[56:59], v[152:155]
    v_cvt_pk_bf16_f32 v169, v178, v179
    v_exp_f32 v182, v182
    v_mfma_f32_16x16x32_bf16 v[152:155], a[76:79], a[60:63], v[152:155]
    s_waitcnt lgkmcnt(3)
    v_fma_f32 v184, v184, s28, -v216
    v_exp_f32 v183, v183
    v_mfma_f32_16x16x32_bf16 v[132:135], a[80:83], a[0:3], 0
    s_waitcnt lgkmcnt(2)
    v_fma_f32 v185, v185, s28, -v216
    v_mfma_f32_16x16x32_bf16 v[132:135], a[84:87], a[4:7], v[132:135]
    s_waitcnt lgkmcnt(1)
    v_cvt_pk_bf16_f32 v170, v180, v181
    v_exp_f32 v184, v184
    v_mfma_f32_16x16x32_bf16 v[132:135], a[88:91], a[8:11], v[132:135]
    s_waitcnt lgkmcnt(0)
    ds_read_b64_tr_b16 a[96:97], v196 offset:24576
    v_fma_f32 v186, v186, s28, -v216
    v_mfma_f32_16x16x32_bf16 v[132:135], a[92:95], a[12:15], v[132:135]
    ds_read_b64_tr_b16 a[98:99], v196 offset:28672
    v_exp_f32 v185, v185
    v_fma_f32 v187, v187, s28, -v216
    v_mfma_f32_16x16x32_bf16 v[140:143], a[80:83], a[16:19], 0
    v_cvt_pk_bf16_f32 v171, v182, v183
    v_mfma_f32_16x16x32_bf16 v[140:143], a[84:87], a[20:23], v[140:143]
    v_exp_f32 v186, v186
    v_fma_f32 v188, v188, s28, -v216
    v_mfma_f32_16x16x32_bf16 v[140:143], a[88:91], a[24:27], v[140:143]
    v_exp_f32 v187, v187
    v_fma_f32 v189, v189, s28, -v216
    v_mfma_f32_16x16x32_bf16 v[140:143], a[92:95], a[28:31], v[140:143]
    ds_read_b64_tr_b16 a[100:101], v197 offset:24576
    v_cvt_pk_bf16_f32 v172, v184, v185
    v_mfma_f32_16x16x32_bf16 v[148:151], a[80:83], a[32:35], 0
    ds_read_b64_tr_b16 a[102:103], v197 offset:28672
    v_exp_f32 v188, v188
    v_fma_f32 v190, v190, s28, -v216
    v_mfma_f32_16x16x32_bf16 v[148:151], a[84:87], a[36:39], v[148:151]
    v_exp_f32 v189, v189
    v_mfma_f32_16x16x32_bf16 v[148:151], a[88:91], a[40:43], v[148:151]
    v_fma_f32 v191, v191, s28, -v216
    v_cvt_pk_bf16_f32 v173, v186, v187
    v_mfma_f32_16x16x32_bf16 v[148:151], a[92:95], a[44:47], v[148:151]
    ds_read_b64_tr_b16 a[104:105], v198 offset:24576
    v_exp_f32 v190, v190
    v_mfma_f32_16x16x32_bf16 v[156:159], a[80:83], a[48:51], 0
    ds_read_b64_tr_b16 a[106:107], v198 offset:28672
    v_exp_f32 v191, v191
    v_cvt_pk_bf16_f32 v174, v188, v189
    v_mfma_f32_16x16x32_bf16 v[156:159], a[84:87], a[52:55], v[156:159]
    v_cvt_pk_bf16_f32 v175, v190, v191
    v_mfma_f32_16x16x32_bf16 v[156:159], a[88:91], a[56:59], v[156:159]
    v_mfma_f32_16x16x32_bf16 v[156:159], a[92:95], a[60:63], v[156:159]
    s_waitcnt lgkmcnt(4)
    v_mfma_f32_16x16x32_bf16 v[0:3], a[96:99], v[160:163], v[0:3]
    ds_read_b64_tr_b16 a[108:109], v199 offset:24576
    v_mfma_f32_16x16x32_bf16 v[4:7], a[96:99], v[164:167], v[4:7]
    ds_read_b64_tr_b16 a[110:111], v199 offset:28672
    v_mfma_f32_16x16x32_bf16 a[132:135], a[128:131], v[160:163], a[132:135]
    buffer_store_dwordx4 a[160:163], v212, s[16:19], s29 offen offset:2048 sc1
    v_max3_f32 v229, v128, v129, v130
    v_max3_f32 v230, v136, v137, v138
    v_mfma_f32_16x16x32_bf16 v[8:11], a[96:99], v[168:171], v[8:11]
    v_max3_f32 v231, v144, v145, v146
    v_max3_f32 v232, v152, v153, v154
    v_mfma_f32_16x16x32_bf16 v[12:15], a[96:99], v[172:175], v[12:15]
    s_waitcnt lgkmcnt(4)
    ds_read_b64_tr_b16 a[112:113], v200 offset:24576
    v_max3_f32 v229, v229, v131, v132
    v_max3_f32 v230, v230, v139, v140
    v_mfma_f32_16x16x32_bf16 v[16:19], a[100:103], v[160:163], v[16:19]
    ds_read_b64_tr_b16 a[114:115], v200 offset:28672
    v_max3_f32 v231, v231, v147, v148
    v_max3_f32 v232, v232, v155, v156
    v_mfma_f32_16x16x32_bf16 v[20:23], a[100:103], v[164:167], v[20:23]
    v_max3_f32 v229, v229, v133, v134
    v_max3_f32 v230, v230, v141, v142
    v_mfma_f32_16x16x32_bf16 v[24:27], a[100:103], v[168:171], v[24:27]
    v_max3_f32 v231, v231, v149, v150
    v_max3_f32 v232, v232, v157, v158
    v_mfma_f32_16x16x32_bf16 v[28:31], a[100:103], v[172:175], v[28:31]
    s_waitcnt lgkmcnt(4)
    v_max_f32 v229, v229, v135
    v_max_f32 v230, v230, v143
    v_mfma_f32_16x16x32_bf16 v[32:35], a[104:107], v[160:163], v[32:35]
    ds_read_b64_tr_b16 a[116:117], v201 offset:24576
    v_max_f32 v231, v231, v151
    v_max_f32 v232, v232, v159
    v_mfma_f32_16x16x32_bf16 v[36:39], a[104:107], v[164:167], v[36:39]
    ds_read_b64_tr_b16 a[118:119], v201 offset:28672
    v_mfma_f32_16x16x32_bf16 a[136:139], a[128:131], v[164:167], a[136:139]
    v_cmp_gt_f32 s[32:33], v229, v217
    v_cmp_gt_f32 s[34:35], v230, v218
    v_mfma_f32_16x16x32_bf16 v[40:43], a[104:107], v[168:171], v[40:43]
    v_cmp_gt_f32 s[36:37], v231, v219
    v_cmp_gt_f32 s[38:39], v232, v220
    v_mfma_f32_16x16x32_bf16 v[44:47], a[104:107], v[172:175], v[44:47]
    s_waitcnt lgkmcnt(4)
    ds_read_b64_tr_b16 a[120:121], v202 offset:24576
    s_or_b64 s[32:33], s[32:33], s[34:35]
    s_or_b64 s[36:37], s[36:37], s[38:39]
    v_mfma_f32_16x16x32_bf16 v[48:51], a[108:111], v[160:163], v[48:51]
    ds_read_b64_tr_b16 a[122:123], v202 offset:28672
    s_or_b64 s[32:33], s[32:33], s[36:37]
    s_cbranch_scc1 L_rb1
L_rbr1:
    v_mfma_f32_16x16x32_bf16 v[52:55], a[108:111], v[164:167], v[52:55]
    v_fma_f32 v128, v128, s28, -v213
    v_fma_f32 v129, v129, s28, -v213
    v_mfma_f32_16x16x32_bf16 v[56:59], a[108:111], v[168:171], v[56:59]
    v_exp_f32 v128, v128
    v_fma_f32 v130, v130, s28, -v213
    v_mfma_f32_16x16x32_bf16 v[60:63], a[108:111], v[172:175], v[60:63]
    s_waitcnt lgkmcnt(4)
    v_exp_f32 v129, v129
    v_mfma_f32_16x16x32_bf16 v[64:67], a[112:115], v[160:163], v[64:67]
    ds_read_b128 a[64:67], v192 offset:40960
    ds_read_b64_tr_b16 a[124:125], v203 offset:24576
    v_fma_f32 v131, v131, s28, -v213
    v_exp_f32 v130, v130
    v_mfma_f32_16x16x32_bf16 v[68:71], a[112:115], v[164:167], v[68:71]
    ds_read_b128 a[68:71], v193 offset:40960
    ds_read_b64_tr_b16 a[126:127], v203 offset:28672
    v_fma_f32 v132, v132, s28, -v213
    v_mfma_f32_16x16x32_bf16 a[140:143], a[128:131], v[168:171], a[140:143]
    ds_read_b128 a[72:75], v194 offset:40960
    v_exp_f32 v131, v131
    v_fma_f32 v133, v133, s28, -v213
    v_mfma_f32_16x16x32_bf16 v[72:75], a[112:115], v[168:171], v[72:75]
    ds_read_b128 a[76:79], v195 offset:40960
    v_cvt_pk_bf16_f32 v128, v128, v129
    v_mfma_f32_16x16x32_bf16 v[76:79], a[112:115], v[172:175], v[76:79]
    s_waitcnt lgkmcnt(8)
    v_exp_f32 v132, v132
    v_fma_f32 v134, v134, s28, -v213
    v_mfma_f32_16x16x32_bf16 v[80:83], a[116:119], v[160:163], v[80:83]
    v_exp_f32 v133, v133
    v_fma_f32 v135, v135, s28, -v213
    v_mfma_f32_16x16x32_bf16 v[84:87], a[116:119], v[164:167], v[84:87]
    v_cvt_pk_bf16_f32 v129, v130, v131
    v_mfma_f32_16x16x32_bf16 v[88:91], a[116:119], v[168:171], v[88:91]
    v_exp_f32 v134, v134
    v_fma_f32 v136, v136, s28, -v214
    v_mfma_f32_16x16x32_bf16 v[92:95], a[116:119], v[172:175], v[92:95]
    s_waitcnt vmcnt(12) lgkmcnt(0)
    s_barrier
    buffer_store_dwordx4 a[164:167], v212, s[16:19], s31 offen offset:0 sc1
    v_exp_f32 v135, v135
    v_mfma_f32_16x16x32_bf16 v[96:99], a[120:123], v[160:163], v[96:99]
    v_fma_f32 v137, v137, s28, -v214
    v_cvt_pk_bf16_f32 v130, v132, v133
    v_mfma_f32_16x16x32_bf16 v[100:103], a[120:123], v[164:167], v[100:103]
    v_exp_f32 v136, v136
    v_mfma_f32_16x16x32_bf16 a[144:147], a[128:131], v[172:175], a[144:147]
    v_fma_f32 v138, v138, s28, -v214
    v_exp_f32 v137, v137
    v_mfma_f32_16x16x32_bf16 v[104:107], a[120:123], v[168:171], v[104:107]
    s_xor_b32 m0, s24, 0xc000
    s_add_u32 s23, s20, 0xc000
    buffer_load_dwordx4 v208, s[12:15], s23 offen nt lds
    v_fma_f32 v139, v139, s28, -v214
    v_cvt_pk_bf16_f32 v131, v134, v135
    v_mfma_f32_16x16x32_bf16 v[108:111], a[120:123], v[172:175], v[108:111]
    v_exp_f32 v138, v138
    v_mfma_f32_16x16x32_bf16 v[112:115], a[124:127], v[160:163], v[112:115]
    buffer_load_dwordx4 v209, s[12:15], s23 offen offset:1024 nt lds
    v_fma_f32 v140, v140, s28, -v214
    v_exp_f32 v139, v139
    v_mfma_f32_16x16x32_bf16 v[116:119], a[124:127], v[164:167], v[116:119]
    v_fma_f32 v141, v141, s28, -v214
    v_mfma_f32_16x16x32_bf16 v[120:123], a[124:127], v[168:171], v[120:123]
    buffer_load_dwordx4 v208, s[12:15], s23 offen offset:2048 nt lds
    v_cvt_pk_bf16_f32 v132, v136, v137
    v_exp_f32 v140, v140
    v_mfma_f32_16x16x32_bf16 v[124:127], a[124:127], v[172:175], v[124:127]
    s_cmp_lg_u32 s27, 0
    s_cbranch_scc1 L_rc1
L_rcr1:
    v_fma_f32 v142, v142, s28, -v214
    v_mfma_f32_16x16x32_bf16 v[160:163], a[64:67], a[0:3], 0
    buffer_load_dwordx4 v209, s[12:15], s23 offen offset:3072 nt lds
    v_exp_f32 v141, v141
    v_fma_f32 v143, v143, s28, -v214
    v_mfma_f32_16x16x32_bf16 v[160:163], a[68:71], a[4:7], v[160:163]
    v_cvt_pk_bf16_f32 v133, v138, v139
    v_exp_f32 v142, v142
    v_mfma_f32_16x16x32_bf16 v[160:163], a[72:75], a[8:11], v[160:163]
    ds_read_b128 a[80:83], v192 offset:45056
    v_fma_f32 v144, v144, s28, -v215
    v_mfma_f32_16x16x32_bf16 v[160:163], a[76:79], a[12:15], v[160:163]
    ds_read_b128 a[84:87], v193 offset:45056
    v_exp_f32 v143, v143
    v_fma_f32 v145, v145, s28, -v215
    v_mfma_f32_16x16x32_bf16 v[168:171], a[64:67], a[16:19], 0
    ds_read_b128 a[88:91], v194 offset:45056
    v_cvt_pk_bf16_f32 v134, v140, v141
    v_mfma_f32_16x16x32_bf16 v[168:171], a[68:71], a[20:23], v[168:171]
    ds_read_b128 a[92:95], v195 offset:45056
    v_exp_f32 v144, v144
    v_fma_f32 v146, v146, s28, -v215
    v_mfma_f32_16x16x32_bf16 v[168:171], a[72:75], a[24:27], v[168:171]
    v_exp_f32 v145, v145
    v_mfma_f32_16x16x32_bf16 v[168:171], a[76:79], a[28:31], v[168:171]
    v_fma_f32 v147, v147, s28, -v215
    v_cvt_pk_bf16_f32 v135, v142, v143
    v_mfma_f32_16x16x32_bf16 v[176:179], a[64:67], a[32:35], 0
    v_exp_f32 v146, v146
    v_fma_f32 v148, v148, s28, -v215
    v_mfma_f32_16x16x32_bf16 v[176:179], a[68:71], a[36:39], v[176:179]
    v_exp_f32 v147, v147
    v_mfma_f32_16x16x32_bf16 v[176:179], a[72:75], a[40:43], v[176:179]
    v_xor_b32 v192, 0x10000, v192
    v_fma_f32 v149, v149, s28, -v215
    v_cvt_pk_bf16_f32 v136, v144, v145
    v_mfma_f32_16x16x32_bf16 v[176:179], a[76:79], a[44:47], v[176:179]
    v_xor_b32 v193, 0x10000, v193
    v_exp_f32 v148, v148
    v_mfma_f32_16x16x32_bf16 v[184:187], a[64:67], a[48:51], 0
    v_xor_b32 v194, 0x10000, v194
    v_fma_f32 v150, v150, s28, -v215
    v_exp_f32 v149, v149
    v_mfma_f32_16x16x32_bf16 v[184:187], a[68:71], a[52:55], v[184:187]
    v_xor_b32 v195, 0x10000, v195
    v_fma_f32 v151, v151, s28, -v215
    v_mfma_f32_16x16x32_bf16 v[184:187], a[72:75], a[56:59], v[184:187]
    s_xor_b32 m0, s24, 0x10000
    s_add_u32 s23, s21, 0x0
    buffer_load_dwordx4 v204, s[72:75], s23 offen nt lds
    buffer_store_dwordx4 a[168:171], v212, s[16:19], s31 offen offset:2048 sc1
    v_cvt_pk_bf16_f32 v137, v146, v147
    v_exp_f32 v150, v150
    v_mfma_f32_16x16x32_bf16 v[184:187], a[76:79], a[60:63], v[184:187]
    s_waitcnt lgkmcnt(3)
    v_fma_f32 v152, v152, s28, -v216
    v_exp_f32 v151, v151
    v_mfma_f32_16x16x32_bf16 v[164:167], a[80:83], a[0:3], 0
    s_waitcnt lgkmcnt(2)
    buffer_load_dwordx4 v205, s[72:75], s23 offen offset:1024 nt lds
    v_fma_f32 v153, v153, s28, -v216
    v_mfma_f32_16x16x32_bf16 v[164:167], a[84:87], a[4:7], v[164:167]
    s_waitcnt lgkmcnt(1)
    v_cvt_pk_bf16_f32 v138, v148, v149
    v_exp_f32 v152, v152
    v_mfma_f32_16x16x32_bf16 v[164:167], a[88:91], a[8:11], v[164:167]
    s_waitcnt lgkmcnt(0)
    ds_read_b64_tr_b16 a[96:97], v196 offset:49152
    buffer_load_dwordx4 v206, s[72:75], s23 offen offset:2048 nt lds
    v_fma_f32 v154, v154, s28, -v216
    v_mfma_f32_16x16x32_bf16 v[164:167], a[92:95], a[12:15], v[164:167]
    ds_read_b64_tr_b16 a[98:99], v196 offset:53248
    v_exp_f32 v153, v153
    v_fma_f32 v155, v155, s28, -v216
    v_mfma_f32_16x16x32_bf16 v[172:175], a[80:83], a[16:19], 0
    buffer_load_dwordx4 v207, s[72:75], s23 offen offset:3072 nt lds
    v_cvt_pk_bf16_f32 v139, v150, v151
    v_mfma_f32_16x16x32_bf16 v[172:175], a[84:87], a[20:23], v[172:175]
    v_exp_f32 v154, v154
    v_fma_f32 v156, v156, s28, -v216
    v_mfma_f32_16x16x32_bf16 v[172:175], a[88:91], a[24:27], v[172:175]
    v_exp_f32 v155, v155
    v_fma_f32 v157, v157, s28, -v216
    v_mfma_f32_16x16x32_bf16 v[172:175], a[92:95], a[28:31], v[172:175]
    ds_read_b64_tr_b16 a[100:101], v197 offset:49152
    v_cvt_pk_bf16_f32 v140, v152, v153
    v_mfma_f32_16x16x32_bf16 v[180:183], a[80:83], a[32:35], 0
    ds_read_b64_tr_b16 a[102:103], v197 offset:53248
    v_exp_f32 v156, v156
    v_fma_f32 v158, v158, s28, -v216
    v_mfma_f32_16x16x32_bf16 v[180:183], a[84:87], a[36:39], v[180:183]
    v_exp_f32 v157, v157
    v_mfma_f32_16x16x32_bf16 v[180:183], a[88:91], a[40:43], v[180:183]
    v_fma_f32 v159, v159, s28, -v216
    v_cvt_pk_bf16_f32 v141, v154, v155
    v_mfma_f32_16x16x32_bf16 v[180:183], a[92:95], a[44:47], v[180:183]
    ds_read_b64_tr_b16 a[104:105], v198 offset:49152
    v_exp_f32 v158, v158
    v_mfma_f32_16x16x32_bf16 v[188:191], a[80:83], a[48:51], 0
    ds_read_b64_tr_b16 a[106:107], v198 offset:53248
    v_exp_f32 v159, v159
    v_cvt_pk_bf16_f32 v142, v156, v157
    v_mfma_f32_16x16x32_bf16 v[188:191], a[84:87], a[52:55], v[188:191]
    v_cvt_pk_bf16_f32 v143, v158, v159
    v_mfma_f32_16x16x32_bf16 v[188:191], a[88:91], a[56:59], v[188:191]
    v_mfma_f32_16x16x32_bf16 v[188:191], a[92:95], a[60:63], v[188:191]
    s_waitcnt lgkmcnt(4)
    v_mfma_f32_16x16x32_bf16 v[0:3], a[96:99], v[128:131], v[0:3]
    ds_read_b64_tr_b16 a[108:109], v199 offset:49152
    v_mfma_f32_16x16x32_bf16 v[4:7], a[96:99], v[132:135], v[4:7]
    ds_read_b64_tr_b16 a[110:111], v199 offset:53248
    v_mfma_f32_16x16x32_bf16 a[132:135], a[128:131], v[128:131], a[132:135]
    v_max3_f32 v229, v160, v161, v162
    v_max3_f32 v230, v168, v169, v170
    v_mfma_f32_16x16x32_bf16 v[8:11], a[96:99], v[136:139], v[8:11]
    v_max3_f32 v231, v176, v177, v178
    v_max3_f32 v232, v184, v185, v186
    v_mfma_f32_16x16x32_bf16 v[12:15], a[96:99], v[140:143], v[12:15]
    s_waitcnt lgkmcnt(4)
    ds_read_b64_tr_b16 a[112:113], v200 offset:49152
    v_max3_f32 v229, v229, v163, v164
    v_max3_f32 v230, v230, v171, v172
    v_mfma_f32_16x16x32_bf16 v[16:19], a[100:103], v[128:131], v[16:19]
    ds_read_b64_tr_b16 a[114:115], v200 offset:53248
    v_max3_f32 v231, v231, v179, v180
    v_max3_f32 v232, v232, v187, v188
    v_mfma_f32_16x16x32_bf16 v[20:23], a[100:103], v[132:135], v[20:23]
    buffer_store_dwordx4 a[172:175], v212, s[16:19], s44 offen offset:0 sc1
    v_max3_f32 v229, v229, v165, v166
    v_max3_f32 v230, v230, v173, v174
    v_mfma_f32_16x16x32_bf16 v[24:27], a[100:103], v[136:139], v[24:27]
    v_max3_f32 v231, v231, v181, v182
    v_max3_f32 v232, v232, v189, v190
    v_mfma_f32_16x16x32_bf16 v[28:31], a[100:103], v[140:143], v[28:31]
    s_waitcnt lgkmcnt(4)
    v_max_f32 v229, v229, v167
    v_max_f32 v230, v230, v175
    v_mfma_f32_16x16x32_bf16 v[32:35], a[104:107], v[128:131], v[32:35]
    ds_read_b64_tr_b16 a[116:117], v201 offset:49152
    v_max_f32 v231, v231, v183
    v_max_f32 v232, v232, v191
    v_mfma_f32_16x16x32_bf16 v[36:39], a[104:107], v[132:135], v[36:39]
    ds_read_b64_tr_b16 a[118:119], v201 offset:53248
    v_mfma_f32_16x16x32_bf16 a[136:139], a[128:131], v[132:135], a[136:139]
    v_cmp_gt_f32 s[32:33], v229, v217
    v_cmp_gt_f32 s[34:35], v230, v218
    v_mfma_f32_16x16x32_bf16 v[40:43], a[104:107], v[136:139], v[40:43]
    v_cmp_gt_f32 s[36:37], v231, v219
    v_cmp_gt_f32 s[38:39], v232, v220
    v_mfma_f32_16x16x32_bf16 v[44:47], a[104:107], v[140:143], v[44:47]
    s_waitcnt lgkmcnt(4)
    ds_read_b64_tr_b16 a[120:121], v202 offset:49152
    s_or_b64 s[32:33], s[32:33], s[34:35]
    s_or_b64 s[36:37], s[36:37], s[38:39]
    v_mfma_f32_16x16x32_bf16 v[48:51], a[108:111], v[128:131], v[48:51]
    ds_read_b64_tr_b16 a[122:123], v202 offset:53248
    s_or_b64 s[32:33], s[32:33], s[36:37]
    s_cbranch_scc1 L_rb2
L_rbr2:
    v_mfma_f32_16x16x32_bf16 v[52:55], a[108:111], v[132:135], v[52:55]
    v_fma_f32 v160, v160, s28, -v213
    v_fma_f32 v161, v161, s28, -v213
    v_mfma_f32_16x16x32_bf16 v[56:59], a[108:111], v[136:139], v[56:59]
    v_exp_f32 v160, v160
    v_fma_f32 v162, v162, s28, -v213
    v_mfma_f32_16x16x32_bf16 v[60:63], a[108:111], v[140:143], v[60:63]
    s_waitcnt lgkmcnt(4)
    v_exp_f32 v161, v161
    v_mfma_f32_16x16x32_bf16 v[64:67], a[112:115], v[128:131], v[64:67]
    ds_read_b64_tr_b16 a[124:125], v203 offset:49152
    v_fma_f32 v163, v163, s28, -v213
    v_exp_f32 v162, v162
    v_mfma_f32_16x16x32_bf16 v[68:71], a[112:115], v[132:135], v[68:71]
    ds_read_b64_tr_b16 a[126:127], v203 offset:53248
    v_fma_f32 v164, v164, s28, -v213
    v_mfma_f32_16x16x32_bf16 a[140:143], a[128:131], v[136:139], a[140:143]
    v_exp_f32 v163, v163
    v_fma_f32 v165, v165, s28, -v213
    v_mfma_f32_16x16x32_bf16 v[72:75], a[112:115], v[136:139], v[72:75]
    v_cvt_pk_bf16_f32 v160, v160, v161
    v_mfma_f32_16x16x32_bf16 v[76:79], a[112:115], v[140:143], v[76:79]
    s_waitcnt lgkmcnt(4)
    v_exp_f32 v164, v164
    v_fma_f32 v166, v166, s28, -v213
    v_mfma_f32_16x16x32_bf16 v[80:83], a[116:119], v[128:131], v[80:83]
    v_exp_f32 v165, v165
    v_fma_f32 v167, v167, s28, -v213
    v_mfma_f32_16x16x32_bf16 v[84:87], a[116:119], v[132:135], v[84:87]
    v_cvt_pk_bf16_f32 v161, v162, v163
    v_mfma_f32_16x16x32_bf16 v[88:91], a[116:119], v[136:139], v[88:91]
    v_exp_f32 v166, v166
    v_fma_f32 v168, v168, s28, -v214
    v_mfma_f32_16x16x32_bf16 v[92:95], a[116:119], v[140:143], v[92:95]
    s_waitcnt vmcnt(27) lgkmcnt(0)
    s_barrier
    ds_read_b128 a[64:67], v192 offset:0
    v_exp_f32 v167, v167
    v_mfma_f32_16x16x32_bf16 v[96:99], a[120:123], v[128:131], v[96:99]
    ds_read_b128 a[68:71], v193 offset:0
    v_fma_f32 v169, v169, s28, -v214
    v_cvt_pk_bf16_f32 v162, v164, v165
    v_mfma_f32_16x16x32_bf16 v[100:103], a[120:123], v[132:135], v[100:103]
    ds_read_b128 a[72:75], v194 offset:0
    v_exp_f32 v168, v168
    v_mfma_f32_16x16x32_bf16 a[144:147], a[128:131], v[140:143], a[144:147]
    ds_read_b128 a[76:79], v195 offset:0
    v_fma_f32 v170, v170, s28, -v214
    v_exp_f32 v169, v169
    v_mfma_f32_16x16x32_bf16 v[104:107], a[120:123], v[136:139], v[104:107]
    s_xor_b32 m0, s24, 0x14000
    s_add_u32 s23, s21, 0x4000
    buffer_load_dwordx4 v204, s[72:75], s23 offen nt lds
    buffer_store_dwordx4 a[176:179], v212, s[16:19], s44 offen offset:2048 sc1
    v_fma_f32 v171, v171, s28, -v214
    v_cvt_pk_bf16_f32 v163, v166, v167
    v_mfma_f32_16x16x32_bf16 v[108:111], a[120:123], v[140:143], v[108:111]
    v_exp_f32 v170, v170
    v_mfma_f32_16x16x32_bf16 v[112:115], a[124:127], v[128:131], v[112:115]
    buffer_load_dwordx4 v205, s[72:75], s23 offen offset:1024 nt lds
    v_fma_f32 v172, v172, s28, -v214
    v_exp_f32 v171, v171
    v_mfma_f32_16x16x32_bf16 v[116:119], a[124:127], v[132:135], v[116:119]
    v_fma_f32 v173, v173, s28, -v214
    v_mfma_f32_16x16x32_bf16 v[120:123], a[124:127], v[136:139], v[120:123]
    buffer_load_dwordx4 v206, s[72:75], s23 offen offset:2048 nt lds
    v_cvt_pk_bf16_f32 v164, v168, v169
    v_exp_f32 v172, v172
    v_mfma_f32_16x16x32_bf16 v[124:127], a[124:127], v[140:143], v[124:127]
    s_cmp_lg_u32 s27, 0
    s_cbranch_scc1 L_rc2
L_rcr2:
    v_fma_f32 v174, v174, s28, -v214
    s_waitcnt lgkmcnt(3)
    v_mfma_f32_16x16x32_bf16 v[128:131], a[64:67], a[0:3], 0
    s_waitcnt lgkmcnt(2)
    buffer_load_dwordx4 v207, s[72:75], s23 offen offset:3072 nt lds
    v_exp_f32 v173, v173
    v_fma_f32 v175, v175, s28, -v214
    v_mfma_f32_16x16x32_bf16 v[128:131], a[68:71], a[4:7], v[128:131]
    s_waitcnt lgkmcnt(1)
    v_cvt_pk_bf16_f32 v165, v170, v171
    v_exp_f32 v174, v174
    v_mfma_f32_16x16x32_bf16 v[128:131], a[72:75], a[8:11], v[128:131]
    s_waitcnt lgkmcnt(0)
    ds_read_b128 a[80:83], v192 offset:4096
    v_fma_f32 v176, v176, s28, -v215
    v_mfma_f32_16x16x32_bf16 v[128:131], a[76:79], a[12:15], v[128:131]
    ds_read_b128 a[84:87], v193 offset:4096
    v_exp_f32 v175, v175
    v_fma_f32 v177, v177, s28, -v215
    v_mfma_f32_16x16x32_bf16 v[136:139], a[64:67], a[16:19], 0
    ds_read_b128 a[88:91], v194 offset:4096
    v_cvt_pk_bf16_f32 v166, v172, v173
    v_mfma_f32_16x16x32_bf16 v[136:139], a[68:71], a[20:23], v[136:139]
    ds_read_b128 a[92:95], v195 offset:4096
    v_exp_f32 v176, v176
    v_fma_f32 v178, v178, s28, -v215
    v_mfma_f32_16x16x32_bf16 v[136:139], a[72:75], a[24:27], v[136:139]
    v_exp_f32 v177, v177
    v_mfma_f32_16x16x32_bf16 v[136:139], a[76:79], a[28:31], v[136:139]
    v_fma_f32 v179, v179, s28, -v215
    v_cvt_pk_bf16_f32 v167, v174, v175
    v_mfma_f32_16x16x32_bf16 v[144:147], a[64:67], a[32:35], 0
    v_exp_f32 v178, v178
    v_fma_f32 v180, v180, s28, -v215
    v_mfma_f32_16x16x32_bf16 v[144:147], a[68:71], a[36:39], v[144:147]
    v_exp_f32 v179, v179
    v_mfma_f32_16x16x32_bf16 v[144:147], a[72:75], a[40:43], v[144:147]
    v_fma_f32 v181, v181, s28, -v215
    v_cvt_pk_bf16_f32 v168, v176, v177
    v_mfma_f32_16x16x32_bf16 v[144:147], a[76:79], a[44:47], v[144:147]
    v_exp_f32 v180, v180
    v_mfma_f32_16x16x32_bf16 v[152:155], a[64:67], a[48:51], 0
    v_fma_f32 v182, v182, s28, -v215
    v_exp_f32 v181, v181
    v_mfma_f32_16x16x32_bf16 v[152:155], a[68:71], a[52:55], v[152:155]
    v_fma_f32 v183, v183, s28, -v215
    v_mfma_f32_16x16x32_bf16 v[152:155], a[72:75], a[56:59], v[152:155]
    v_cvt_pk_bf16_f32 v169, v178, v179
    v_exp_f32 v182, v182
    v_mfma_f32_16x16x32_bf16 v[152:155], a[76:79], a[60:63], v[152:155]
    s_waitcnt lgkmcnt(3)
    v_fma_f32 v184, v184, s28, -v216
    v_exp_f32 v183, v183
    v_mfma_f32_16x16x32_bf16 v[132:135], a[80:83], a[0:3], 0
    s_waitcnt lgkmcnt(2)
    v_fma_f32 v185, v185, s28, -v216
    v_mfma_f32_16x16x32_bf16 v[132:135], a[84:87], a[4:7], v[132:135]
    s_waitcnt lgkmcnt(1)
    v_cvt_pk_bf16_f32 v170, v180, v181
    v_exp_f32 v184, v184
    v_mfma_f32_16x16x32_bf16 v[132:135], a[88:91], a[8:11], v[132:135]
    s_waitcnt lgkmcnt(0)
    ds_read_b64_tr_b16 a[96:97], v196 offset:57344
    buffer_store_dwordx4 a[180:183], v212, s[16:19], s22 offen offset:128 sc1
    v_fma_f32 v186, v186, s28, -v216
    v_mfma_f32_16x16x32_bf16 v[132:135], a[92:95], a[12:15], v[132:135]
    ds_read_b64_tr_b16 a[98:99], v196 offset:61440
    v_exp_f32 v185, v185
    v_fma_f32 v187, v187, s28, -v216
    v_mfma_f32_16x16x32_bf16 v[140:143], a[80:83], a[16:19], 0
    v_cvt_pk_bf16_f32 v171, v182, v183
    v_mfma_f32_16x16x32_bf16 v[140:143], a[84:87], a[20:23], v[140:143]
    v_exp_f32 v186, v186
    v_fma_f32 v188, v188, s28, -v216
    v_mfma_f32_16x16x32_bf16 v[140:143], a[88:91], a[24:27], v[140:143]
    v_exp_f32 v187, v187
    v_fma_f32 v189, v189, s28, -v216
    v_mfma_f32_16x16x32_bf16 v[140:143], a[92:95], a[28:31], v[140:143]
    ds_read_b64_tr_b16 a[100:101], v197 offset:57344
    v_cvt_pk_bf16_f32 v172, v184, v185
    v_mfma_f32_16x16x32_bf16 v[148:151], a[80:83], a[32:35], 0
    ds_read_b64_tr_b16 a[102:103], v197 offset:61440
    v_exp_f32 v188, v188
    v_fma_f32 v190, v190, s28, -v216
    v_mfma_f32_16x16x32_bf16 v[148:151], a[84:87], a[36:39], v[148:151]
    v_exp_f32 v189, v189
    v_mfma_f32_16x16x32_bf16 v[148:151], a[88:91], a[40:43], v[148:151]
    v_fma_f32 v191, v191, s28, -v216
    v_cvt_pk_bf16_f32 v173, v186, v187
    v_mfma_f32_16x16x32_bf16 v[148:151], a[92:95], a[44:47], v[148:151]
    ds_read_b64_tr_b16 a[104:105], v198 offset:57344
    v_exp_f32 v190, v190
    v_mfma_f32_16x16x32_bf16 v[156:159], a[80:83], a[48:51], 0
    ds_read_b64_tr_b16 a[106:107], v198 offset:61440
    v_exp_f32 v191, v191
    v_cvt_pk_bf16_f32 v174, v188, v189
    v_mfma_f32_16x16x32_bf16 v[156:159], a[84:87], a[52:55], v[156:159]
    v_cvt_pk_bf16_f32 v175, v190, v191
    v_mfma_f32_16x16x32_bf16 v[156:159], a[88:91], a[56:59], v[156:159]
    v_mfma_f32_16x16x32_bf16 v[156:159], a[92:95], a[60:63], v[156:159]
    s_waitcnt lgkmcnt(4)
    v_mfma_f32_16x16x32_bf16 v[0:3], a[96:99], v[160:163], v[0:3]
    ds_read_b64_tr_b16 a[108:109], v199 offset:57344
    v_mfma_f32_16x16x32_bf16 v[4:7], a[96:99], v[164:167], v[4:7]
    ds_read_b64_tr_b16 a[110:111], v199 offset:61440
    v_mfma_f32_16x16x32_bf16 a[132:135], a[128:131], v[160:163], a[132:135]
    v_max3_f32 v229, v128, v129, v130
    v_max3_f32 v230, v136, v137, v138
    v_mfma_f32_16x16x32_bf16 v[8:11], a[96:99], v[168:171], v[8:11]
    v_max3_f32 v231, v144, v145, v146
    v_max3_f32 v232, v152, v153, v154
    v_mfma_f32_16x16x32_bf16 v[12:15], a[96:99], v[172:175], v[12:15]
    s_waitcnt lgkmcnt(4)
    ds_read_b64_tr_b16 a[112:113], v200 offset:57344
    v_max3_f32 v229, v229, v131, v132
    v_max3_f32 v230, v230, v139, v140
    v_mfma_f32_16x16x32_bf16 v[16:19], a[100:103], v[160:163], v[16:19]
    ds_read_b64_tr_b16 a[114:115], v200 offset:61440
    v_max3_f32 v231, v231, v147, v148
    v_max3_f32 v232, v232, v155, v156
    v_mfma_f32_16x16x32_bf16 v[20:23], a[100:103], v[164:167], v[20:23]
    v_max3_f32 v229, v229, v133, v134
    v_max3_f32 v230, v230, v141, v142
    v_mfma_f32_16x16x32_bf16 v[24:27], a[100:103], v[168:171], v[24:27]
    v_max3_f32 v231, v231, v149, v150
    v_max3_f32 v232, v232, v157, v158
    v_mfma_f32_16x16x32_bf16 v[28:31], a[100:103], v[172:175], v[28:31]
    s_waitcnt lgkmcnt(4)
    v_max_f32 v229, v229, v135
    v_max_f32 v230, v230, v143
    v_mfma_f32_16x16x32_bf16 v[32:35], a[104:107], v[160:163], v[32:35]
    ds_read_b64_tr_b16 a[116:117], v201 offset:57344
    v_max_f32 v231, v231, v151
    v_max_f32 v232, v232, v159
    v_mfma_f32_16x16x32_bf16 v[36:39], a[104:107], v[164:167], v[36:39]
    ds_read_b64_tr_b16 a[118:119], v201 offset:61440
    buffer_store_dwordx4 a[184:187], v212, s[16:19], s22 offen offset:2176 sc1
    v_mfma_f32_16x16x32_bf16 a[136:139], a[128:131], v[164:167], a[136:139]
    v_cmp_gt_f32 s[32:33], v229, v217
    v_cmp_gt_f32 s[34:35], v230, v218
    v_mfma_f32_16x16x32_bf16 v[40:43], a[104:107], v[168:171], v[40:43]
    v_cmp_gt_f32 s[36:37], v231, v219
    v_cmp_gt_f32 s[38:39], v232, v220
    v_mfma_f32_16x16x32_bf16 v[44:47], a[104:107], v[172:175], v[44:47]
    s_waitcnt lgkmcnt(4)
    ds_read_b64_tr_b16 a[120:121], v202 offset:57344
    s_or_b64 s[32:33], s[32:33], s[34:35]
    s_or_b64 s[36:37], s[36:37], s[38:39]
    v_mfma_f32_16x16x32_bf16 v[48:51], a[108:111], v[160:163], v[48:51]
    ds_read_b64_tr_b16 a[122:123], v202 offset:61440
    s_or_b64 s[32:33], s[32:33], s[36:37]
    s_cbranch_scc1 L_rb3
L_rbr3:
    v_mfma_f32_16x16x32_bf16 v[52:55], a[108:111], v[164:167], v[52:55]
    v_fma_f32 v128, v128, s28, -v213
    v_fma_f32 v129, v129, s28, -v213
    v_mfma_f32_16x16x32_bf16 v[56:59], a[108:111], v[168:171], v[56:59]
    v_exp_f32 v128, v128
    v_fma_f32 v130, v130, s28, -v213
    v_mfma_f32_16x16x32_bf16 v[60:63], a[108:111], v[172:175], v[60:63]
    s_waitcnt lgkmcnt(4)
    v_exp_f32 v129, v129
    v_mfma_f32_16x16x32_bf16 v[64:67], a[112:115], v[160:163], v[64:67]
    ds_read_b128 a[64:67], v192 offset:8192
    ds_read_b64_tr_b16 a[124:125], v203 offset:57344
    v_fma_f32 v131, v131, s28, -v213
    v_exp_f32 v130, v130
    v_mfma_f32_16x16x32_bf16 v[68:71], a[112:115], v[164:167], v[68:71]
    ds_read_b128 a[68:71], v193 offset:8192
    ds_read_b64_tr_b16 a[126:127], v203 offset:61440
    v_fma_f32 v132, v132, s28, -v213
    v_mfma_f32_16x16x32_bf16 a[140:143], a[128:131], v[168:171], a[140:143]
    ds_read_b128 a[72:75], v194 offset:8192
    v_exp_f32 v131, v131
    v_fma_f32 v133, v133, s28, -v213
    v_mfma_f32_16x16x32_bf16 v[72:75], a[112:115], v[168:171], v[72:75]
    ds_read_b128 a[76:79], v195 offset:8192
    v_cvt_pk_bf16_f32 v128, v128, v129
    v_mfma_f32_16x16x32_bf16 v[76:79], a[112:115], v[172:175], v[76:79]
    s_waitcnt lgkmcnt(8)
    v_exp_f32 v132, v132
    v_fma_f32 v134, v134, s28, -v213
    v_mfma_f32_16x16x32_bf16 v[80:83], a[116:119], v[160:163], v[80:83]
    v_exp_f32 v133, v133
    v_fma_f32 v135, v135, s28, -v213
    v_mfma_f32_16x16x32_bf16 v[84:87], a[116:119], v[164:167], v[84:87]
    v_cvt_pk_bf16_f32 v129, v130, v131
    v_mfma_f32_16x16x32_bf16 v[88:91], a[116:119], v[168:171], v[88:91]
    v_exp_f32 v134, v134
    v_fma_f32 v136, v136, s28, -v214
    v_mfma_f32_16x16x32_bf16 v[92:95], a[116:119], v[172:175], v[92:95]
    s_waitcnt vmcnt(26) lgkmcnt(0)
    s_barrier
    v_exp_f32 v135, v135
    v_mfma_f32_16x16x32_bf16 v[96:99], a[120:123], v[160:163], v[96:99]
    v_fma_f32 v137, v137, s28, -v214
    v_cvt_pk_bf16_f32 v130, v132, v133
    v_mfma_f32_16x16x32_bf16 v[100:103], a[120:123], v[164:167], v[100:103]
    v_exp_f32 v136, v136
    v_mfma_f32_16x16x32_bf16 a[144:147], a[128:131], v[172:175], a[144:147]
    v_fma_f32 v138, v138, s28, -v214
    v_exp_f32 v137, v137
    v_mfma_f32_16x16x32_bf16 v[104:107], a[120:123], v[168:171], v[104:107]
    s_xor_b32 m0, s24, 0x18000
    s_add_u32 s23, s21, 0x8000
    buffer_load_dwordx4 v204, s[72:75], s23 offen nt lds
    v_fma_f32 v139, v139, s28, -v214
    v_cvt_pk_bf16_f32 v131, v134, v135
    v_mfma_f32_16x16x32_bf16 v[108:111], a[120:123], v[172:175], v[108:111]
    v_exp_f32 v138, v138
    v_mfma_f32_16x16x32_bf16 v[112:115], a[124:127], v[160:163], v[112:115]
    buffer_load_dwordx4 v205, s[72:75], s23 offen offset:1024 nt lds
    v_fma_f32 v140, v140, s28, -v214
    v_exp_f32 v139, v139
    v_mfma_f32_16x16x32_bf16 v[116:119], a[124:127], v[164:167], v[116:119]
    v_fma_f32 v141, v141, s28, -v214
    v_mfma_f32_16x16x32_bf16 v[120:123], a[124:127], v[168:171], v[120:123]
    buffer_load_dwordx4 v206, s[72:75], s23 offen offset:2048 nt lds
    buffer_store_dwordx4 a[188:191], v212, s[16:19], s29 offen offset:128 sc1
    v_cvt_pk_bf16_f32 v132, v136, v137
    v_exp_f32 v140, v140
    v_mfma_f32_16x16x32_bf16 v[124:127], a[124:127], v[172:175], v[124:127]
    s_cmp_lg_u32 s27, 0
    s_cbranch_scc1 L_rc3
L_rcr3:
    v_fma_f32 v142, v142, s28, -v214
    v_mfma_f32_16x16x32_bf16 v[160:163], a[64:67], a[0:3], 0
    buffer_load_dwordx4 v207, s[72:75], s23 offen offset:3072 nt lds
    v_exp_f32 v141, v141
    v_fma_f32 v143, v143, s28, -v214
    v_mfma_f32_16x16x32_bf16 v[160:163], a[68:71], a[4:7], v[160:163]
    v_cvt_pk_bf16_f32 v133, v138, v139
    v_exp_f32 v142, v142
    v_mfma_f32_16x16x32_bf16 v[160:163], a[72:75], a[8:11], v[160:163]
    ds_read_b128 a[80:83], v192 offset:12288
    v_xor_b32 v196, 0x10000, v196
    v_fma_f32 v144, v144, s28, -v215
    v_mfma_f32_16x16x32_bf16 v[160:163], a[76:79], a[12:15], v[160:163]
    ds_read_b128 a[84:87], v193 offset:12288
    v_xor_b32 v197, 0x10000, v197
    v_exp_f32 v143, v143
    v_fma_f32 v145, v145, s28, -v215
    v_mfma_f32_16x16x32_bf16 v[168:171], a[64:67], a[16:19], 0
    ds_read_b128 a[88:91], v194 offset:12288
    v_xor_b32 v198, 0x10000, v198
    v_cvt_pk_bf16_f32 v134, v140, v141
    v_mfma_f32_16x16x32_bf16 v[168:171], a[68:71], a[20:23], v[168:171]
    ds_read_b128 a[92:95], v195 offset:12288
    v_xor_b32 v199, 0x10000, v199
    v_exp_f32 v144, v144
    v_fma_f32 v146, v146, s28, -v215
    v_mfma_f32_16x16x32_bf16 v[168:171], a[72:75], a[24:27], v[168:171]
    v_xor_b32 v200, 0x10000, v200
    v_exp_f32 v145, v145
    v_mfma_f32_16x16x32_bf16 v[168:171], a[76:79], a[28:31], v[168:171]
    v_xor_b32 v201, 0x10000, v201
    v_fma_f32 v147, v147, s28, -v215
    v_cvt_pk_bf16_f32 v135, v142, v143
    v_mfma_f32_16x16x32_bf16 v[176:179], a[64:67], a[32:35], 0
    v_xor_b32 v202, 0x10000, v202
    v_exp_f32 v146, v146
    v_fma_f32 v148, v148, s28, -v215
    v_mfma_f32_16x16x32_bf16 v[176:179], a[68:71], a[36:39], v[176:179]
    v_xor_b32 v203, 0x10000, v203
    v_exp_f32 v147, v147
    v_mfma_f32_16x16x32_bf16 v[176:179], a[72:75], a[40:43], v[176:179]
    v_fma_f32 v149, v149, s28, -v215
    v_cvt_pk_bf16_f32 v136, v144, v145
    v_mfma_f32_16x16x32_bf16 v[176:179], a[76:79], a[44:47], v[176:179]
    v_exp_f32 v148, v148
    v_mfma_f32_16x16x32_bf16 v[184:187], a[64:67], a[48:51], 0
    v_fma_f32 v150, v150, s28, -v215
    v_exp_f32 v149, v149
    v_mfma_f32_16x16x32_bf16 v[184:187], a[68:71], a[52:55], v[184:187]
    v_fma_f32 v151, v151, s28, -v215
    v_mfma_f32_16x16x32_bf16 v[184:187], a[72:75], a[56:59], v[184:187]
    v_cvt_pk_bf16_f32 v137, v146, v147
    v_exp_f32 v150, v150
    v_mfma_f32_16x16x32_bf16 v[184:187], a[76:79], a[60:63], v[184:187]
    s_waitcnt lgkmcnt(3)
    v_fma_f32 v152, v152, s28, -v216
    v_exp_f32 v151, v151
    v_mfma_f32_16x16x32_bf16 v[164:167], a[80:83], a[0:3], 0
    s_waitcnt lgkmcnt(2)
    v_fma_f32 v153, v153, s28, -v216
    v_mfma_f32_16x16x32_bf16 v[164:167], a[84:87], a[4:7], v[164:167]
    s_waitcnt lgkmcnt(1)
    v_cvt_pk_bf16_f32 v138, v148, v149
    v_exp_f32 v152, v152
    v_mfma_f32_16x16x32_bf16 v[164:167], a[88:91], a[8:11], v[164:167]
    s_waitcnt lgkmcnt(0)
    ds_read_b64_tr_b16 a[96:97], v196 offset:16384
    v_fma_f32 v154, v154, s28, -v216
    v_mfma_f32_16x16x32_bf16 v[164:167], a[92:95], a[12:15], v[164:167]
    ds_read_b64_tr_b16 a[98:99], v196 offset:20480
    v_exp_f32 v153, v153
    v_fma_f32 v155, v155, s28, -v216
    v_mfma_f32_16x16x32_bf16 v[172:175], a[80:83], a[16:19], 0
    v_cvt_pk_bf16_f32 v139, v150, v151
    v_mfma_f32_16x16x32_bf16 v[172:175], a[84:87], a[20:23], v[172:175]
    v_exp_f32 v154, v154
    v_fma_f32 v156, v156, s28, -v216
    v_mfma_f32_16x16x32_bf16 v[172:175], a[88:91], a[24:27], v[172:175]
    buffer_store_dwordx4 a[192:195], v212, s[16:19], s29 offen offset:2176 sc1
    v_exp_f32 v155, v155
    v_fma_f32 v157, v157, s28, -v216
    v_mfma_f32_16x16x32_bf16 v[172:175], a[92:95], a[28:31], v[172:175]
    ds_read_b64_tr_b16 a[100:101], v197 offset:16384
    v_cvt_pk_bf16_f32 v140, v152, v153
    v_mfma_f32_16x16x32_bf16 v[180:183], a[80:83], a[32:35], 0
    ds_read_b64_tr_b16 a[102:103], v197 offset:20480
    v_exp_f32 v156, v156
    v_fma_f32 v158, v158, s28, -v216
    v_mfma_f32_16x16x32_bf16 v[180:183], a[84:87], a[36:39], v[180:183]
    v_exp_f32 v157, v157
    v_mfma_f32_16x16x32_bf16 v[180:183], a[88:91], a[40:43], v[180:183]
    v_fma_f32 v159, v159, s28, -v216
    v_cvt_pk_bf16_f32 v141, v154, v155
    v_mfma_f32_16x16x32_bf16 v[180:183], a[92:95], a[44:47], v[180:183]
    ds_read_b64_tr_b16 a[104:105], v198 offset:16384
    v_exp_f32 v158, v158
    v_mfma_f32_16x16x32_bf16 v[188:191], a[80:83], a[48:51], 0
    ds_read_b64_tr_b16 a[106:107], v198 offset:20480
    v_exp_f32 v159, v159
    v_cvt_pk_bf16_f32 v142, v156, v157
    v_mfma_f32_16x16x32_bf16 v[188:191], a[84:87], a[52:55], v[188:191]
    v_cvt_pk_bf16_f32 v143, v158, v159
    v_mfma_f32_16x16x32_bf16 v[188:191], a[88:91], a[56:59], v[188:191]
    v_mfma_f32_16x16x32_bf16 v[188:191], a[92:95], a[60:63], v[188:191]
    s_waitcnt lgkmcnt(4)
    v_mfma_f32_16x16x32_bf16 v[0:3], a[96:99], v[128:131], v[0:3]
    ds_read_b64_tr_b16 a[108:109], v199 offset:16384
    v_mfma_f32_16x16x32_bf16 v[4:7], a[96:99], v[132:135], v[4:7]
    ds_read_b64_tr_b16 a[110:111], v199 offset:20480
    v_mfma_f32_16x16x32_bf16 a[132:135], a[128:131], v[128:131], a[132:135]
    v_max3_f32 v229, v160, v161, v162
    v_max3_f32 v230, v168, v169, v170
    v_mfma_f32_16x16x32_bf16 v[8:11], a[96:99], v[136:139], v[8:11]
    v_max3_f32 v231, v176, v177, v178
    v_max3_f32 v232, v184, v185, v186
    v_mfma_f32_16x16x32_bf16 v[12:15], a[96:99], v[140:143], v[12:15]
    s_waitcnt lgkmcnt(4)
    ds_read_b64_tr_b16 a[112:113], v200 offset:16384
    v_max3_f32 v229, v229, v163, v164
    v_max3_f32 v230, v230, v171, v172
    v_mfma_f32_16x16x32_bf16 v[16:19], a[100:103], v[128:131], v[16:19]
    ds_read_b64_tr_b16 a[114:115], v200 offset:20480
    v_max3_f32 v231, v231, v179, v180
    v_max3_f32 v232, v232, v187, v188
    v_mfma_f32_16x16x32_bf16 v[20:23], a[100:103], v[132:135], v[20:23]
    v_max3_f32 v229, v229, v165, v166
    v_max3_f32 v230, v230, v173, v174
    v_mfma_f32_16x16x32_bf16 v[24:27], a[100:103], v[136:139], v[24:27]
    v_max3_f32 v231, v231, v181, v182
    v_max3_f32 v232, v232, v189, v190
    v_mfma_f32_16x16x32_bf16 v[28:31], a[100:103], v[140:143], v[28:31]
    s_waitcnt lgkmcnt(4)
    v_max_f32 v229, v229, v167
    v_max_f32 v230, v230, v175
    v_mfma_f32_16x16x32_bf16 v[32:35], a[104:107], v[128:131], v[32:35]
    ds_read_b64_tr_b16 a[116:117], v201 offset:16384
    v_max_f32 v231, v231, v183
    v_max_f32 v232, v232, v191
    v_mfma_f32_16x16x32_bf16 v[36:39], a[104:107], v[132:135], v[36:39]
    ds_read_b64_tr_b16 a[118:119], v201 offset:20480
    v_mfma_f32_16x16x32_bf16 a[136:139], a[128:131], v[132:135], a[136:139]
    v_cmp_gt_f32 s[32:33], v229, v217
    v_cmp_gt_f32 s[34:35], v230, v218
    v_mfma_f32_16x16x32_bf16 v[40:43], a[104:107], v[136:139], v[40:43]
    v_cmp_gt_f32 s[36:37], v231, v219
    v_cmp_gt_f32 s[38:39], v232, v220
    v_mfma_f32_16x16x32_bf16 v[44:47], a[104:107], v[140:143], v[44:47]
    s_waitcnt lgkmcnt(4)
    ds_read_b64_tr_b16 a[120:121], v202 offset:16384
    s_or_b64 s[32:33], s[32:33], s[34:35]
    s_or_b64 s[36:37], s[36:37], s[38:39]
    v_mfma_f32_16x16x32_bf16 v[48:51], a[108:111], v[128:131], v[48:51]
    ds_read_b64_tr_b16 a[122:123], v202 offset:20480
    s_or_b64 s[32:33], s[32:33], s[36:37]
    s_cbranch_scc1 L_rb4
L_rbr4:
    buffer_store_dwordx4 a[196:199], v212, s[16:19], s31 offen offset:128 sc1
    v_mfma_f32_16x16x32_bf16 v[52:55], a[108:111], v[132:135], v[52:55]
    v_fma_f32 v160, v160, s28, -v213
    v_fma_f32 v161, v161, s28, -v213
    v_mfma_f32_16x16x32_bf16 v[56:59], a[108:111], v[136:139], v[56:59]
    v_exp_f32 v160, v160
    v_fma_f32 v162, v162, s28, -v213
    v_mfma_f32_16x16x32_bf16 v[60:63], a[108:111], v[140:143], v[60:63]
    s_waitcnt lgkmcnt(4)
    v_exp_f32 v161, v161
    v_mfma_f32_16x16x32_bf16 v[64:67], a[112:115], v[128:131], v[64:67]
    ds_read_b64_tr_b16 a[124:125], v203 offset:16384
    v_fma_f32 v163, v163, s28, -v213
    v_exp_f32 v162, v162
    v_mfma_f32_16x16x32_bf16 v[68:71], a[112:115], v[132:135], v[68:71]
    ds_read_b64_tr_b16 a[126:127], v203 offset:20480
    v_fma_f32 v164, v164, s28, -v213
    v_mfma_f32_16x16x32_bf16 a[140:143], a[128:131], v[136:139], a[140:143]
    v_exp_f32 v163, v163
    v_fma_f32 v165, v165, s28, -v213
    v_mfma_f32_16x16x32_bf16 v[72:75], a[112:115], v[136:139], v[72:75]
    v_cvt_pk_bf16_f32 v160, v160, v161
    v_mfma_f32_16x16x32_bf16 v[76:79], a[112:115], v[140:143], v[76:79]
    s_waitcnt lgkmcnt(4)
    v_exp_f32 v164, v164
    v_fma_f32 v166, v166, s28, -v213
    v_mfma_f32_16x16x32_bf16 v[80:83], a[116:119], v[128:131], v[80:83]
    v_exp_f32 v165, v165
    v_fma_f32 v167, v167, s28, -v213
    v_mfma_f32_16x16x32_bf16 v[84:87], a[116:119], v[132:135], v[84:87]
    v_cvt_pk_bf16_f32 v161, v162, v163
    v_mfma_f32_16x16x32_bf16 v[88:91], a[116:119], v[136:139], v[88:91]
    v_exp_f32 v166, v166
    v_fma_f32 v168, v168, s28, -v214
    v_mfma_f32_16x16x32_bf16 v[92:95], a[116:119], v[140:143], v[92:95]
    s_waitcnt vmcnt(27) lgkmcnt(0)
    s_barrier
    ds_read_b128 a[64:67], v192 offset:32768
    v_exp_f32 v167, v167
    v_mfma_f32_16x16x32_bf16 v[96:99], a[120:123], v[128:131], v[96:99]
    ds_read_b128 a[68:71], v193 offset:32768
    v_fma_f32 v169, v169, s28, -v214
    v_cvt_pk_bf16_f32 v162, v164, v165
    v_mfma_f32_16x16x32_bf16 v[100:103], a[120:123], v[132:135], v[100:103]
    ds_read_b128 a[72:75], v194 offset:32768
    v_exp_f32 v168, v168
    v_mfma_f32_16x16x32_bf16 a[144:147], a[128:131], v[140:143], a[144:147]
    ds_read_b128 a[76:79], v195 offset:32768
    v_fma_f32 v170, v170, s28, -v214
    v_exp_f32 v169, v169
    v_mfma_f32_16x16x32_bf16 v[104:107], a[120:123], v[136:139], v[104:107]
    s_xor_b32 m0, s24, 0x0
    s_add_u32 s23, s21, 0x0
    buffer_load_dwordx4 v204, s[76:79], s23 offen nt lds
    v_fma_f32 v171, v171, s28, -v214
    v_cvt_pk_bf16_f32 v163, v166, v167
    v_mfma_f32_16x16x32_bf16 v[108:111], a[120:123], v[140:143], v[108:111]
    v_exp_f32 v170, v170
    v_mfma_f32_16x16x32_bf16 v[112:115], a[124:127], v[128:131], v[112:115]
    buffer_load_dwordx4 v205, s[76:79], s23 offen offset:1024 nt lds
    v_fma_f32 v172, v172, s28, -v214
    v_exp_f32 v171, v171
    v_mfma_f32_16x16x32_bf16 v[116:119], a[124:127], v[132:135], v[116:119]
    v_fma_f32 v173, v173, s28, -v214
    v_mfma_f32_16x16x32_bf16 v[120:123], a[124:127], v[136:139], v[120:123]
    buffer_load_dwordx4 v206, s[76:79], s23 offen offset:2048 nt lds
    v_cvt_pk_bf16_f32 v164, v168, v169
    v_exp_f32 v172, v172
    v_mfma_f32_16x16x32_bf16 v[124:127], a[124:127], v[140:143], v[124:127]
    s_cmp_lg_u32 s27, 0
    s_cbranch_scc1 L_rc4
L_rcr4:
    v_fma_f32 v174, v174, s28, -v214
    s_waitcnt lgkmcnt(3)
    v_mfma_f32_16x16x32_bf16 v[128:131], a[64:67], a[0:3], 0
    s_waitcnt lgkmcnt(2)
    buffer_load_dwordx4 v207, s[76:79], s23 offen offset:3072 nt lds
    v_exp_f32 v173, v173
    v_fma_f32 v175, v175, s28, -v214
    v_mfma_f32_16x16x32_bf16 v[128:131], a[68:71], a[4:7], v[128:131]
    s_waitcnt lgkmcnt(1)
    v_cvt_pk_bf16_f32 v165, v170, v171
    v_exp_f32 v174, v174
    v_mfma_f32_16x16x32_bf16 v[128:131], a[72:75], a[8:11], v[128:131]
    s_waitcnt lgkmcnt(0)
    ds_read_b128 a[80:83], v192 offset:36864
    buffer_store_dwordx4 a[200:203], v212, s[16:19], s31 offen offset:2176 sc1
    v_fma_f32 v176, v176, s28, -v215
    v_mfma_f32_16x16x32_bf16 v[128:131], a[76:79], a[12:15], v[128:131]
    ds_read_b128 a[84:87], v193 offset:36864
    v_exp_f32 v175, v175
    v_fma_f32 v177, v177, s28, -v215
    v_mfma_f32_16x16x32_bf16 v[136:139], a[64:67], a[16:19], 0
    ds_read_b128 a[88:91], v194 offset:36864
    v_cvt_pk_bf16_f32 v166, v172, v173
    v_mfma_f32_16x16x32_bf16 v[136:139], a[68:71], a[20:23], v[136:139]
    ds_read_b128 a[92:95], v195 offset:36864
    v_exp_f32 v176, v176
    v_fma_f32 v178, v178, s28, -v215
    v_mfma_f32_16x16x32_bf16 v[136:139], a[72:75], a[24:27], v[136:139]
    v_exp_f32 v177, v177
    v_mfma_f32_16x16x32_bf16 v[136:139], a[76:79], a[28:31], v[136:139]
    v_fma_f32 v179, v179, s28, -v215
    v_cvt_pk_bf16_f32 v167, v174, v175
    v_mfma_f32_16x16x32_bf16 v[144:147], a[64:67], a[32:35], 0
    v_exp_f32 v178, v178
    v_fma_f32 v180, v180, s28, -v215
    v_mfma_f32_16x16x32_bf16 v[144:147], a[68:71], a[36:39], v[144:147]
    v_exp_f32 v179, v179
    v_mfma_f32_16x16x32_bf16 v[144:147], a[72:75], a[40:43], v[144:147]
    v_fma_f32 v181, v181, s28, -v215
    v_cvt_pk_bf16_f32 v168, v176, v177
    v_mfma_f32_16x16x32_bf16 v[144:147], a[76:79], a[44:47], v[144:147]
    v_exp_f32 v180, v180
    v_mfma_f32_16x16x32_bf16 v[152:155], a[64:67], a[48:51], 0
    v_fma_f32 v182, v182, s28, -v215
    v_exp_f32 v181, v181
    v_mfma_f32_16x16x32_bf16 v[152:155], a[68:71], a[52:55], v[152:155]
    v_fma_f32 v183, v183, s28, -v215
    v_mfma_f32_16x16x32_bf16 v[152:155], a[72:75], a[56:59], v[152:155]
    s_xor_b32 m0, s24, 0x1c000
    s_add_u32 s23, s21, 0xc000
    buffer_load_dwordx4 v204, s[72:75], s23 offen nt lds
    v_cvt_pk_bf16_f32 v169, v178, v179
    v_exp_f32 v182, v182
    v_mfma_f32_16x16x32_bf16 v[152:155], a[76:79], a[60:63], v[152:155]
    s_waitcnt lgkmcnt(3)
    v_fma_f32 v184, v184, s28, -v216
    v_exp_f32 v183, v183
    v_mfma_f32_16x16x32_bf16 v[132:135], a[80:83], a[0:3], 0
    s_waitcnt lgkmcnt(2)
    buffer_load_dwordx4 v205, s[72:75], s23 offen offset:1024 nt lds
    v_fma_f32 v185, v185, s28, -v216
    v_mfma_f32_16x16x32_bf16 v[132:135], a[84:87], a[4:7], v[132:135]
    s_waitcnt lgkmcnt(1)
    v_cvt_pk_bf16_f32 v170, v180, v181
    v_exp_f32 v184, v184
    v_mfma_f32_16x16x32_bf16 v[132:135], a[88:91], a[8:11], v[132:135]
    s_waitcnt lgkmcnt(0)
    ds_read_b64_tr_b16 a[96:97], v196 offset:24576
    buffer_load_dwordx4 v206, s[72:75], s23 offen offset:2048 nt lds
    v_fma_f32 v186, v186, s28, -v216
    v_mfma_f32_16x16x32_bf16 v[132:135], a[92:95], a[12:15], v[132:135]
    ds_read_b64_tr_b16 a[98:99], v196 offset:28672
    v_exp_f32 v185, v185
    v_fma_f32 v187, v187, s28, -v216
    v_mfma_f32_16x16x32_bf16 v[140:143], a[80:83], a[16:19], 0
    buffer_load_dwordx4 v207, s[72:75], s23 offen offset:3072 nt lds
    v_cvt_pk_bf16_f32 v171, v182, v183
    v_mfma_f32_16x16x32_bf16 v[140:143], a[84:87], a[20:23], v[140:143]
    v_exp_f32 v186, v186
    v_fma_f32 v188, v188, s28, -v216
    v_mfma_f32_16x16x32_bf16 v[140:143], a[88:91], a[24:27], v[140:143]
    v_exp_f32 v187, v187
    v_fma_f32 v189, v189, s28, -v216
    v_mfma_f32_16x16x32_bf16 v[140:143], a[92:95], a[28:31], v[140:143]
    ds_read_b64_tr_b16 a[100:101], v197 offset:24576
    v_cvt_pk_bf16_f32 v172, v184, v185
    v_mfma_f32_16x16x32_bf16 v[148:151], a[80:83], a[32:35], 0
    ds_read_b64_tr_b16 a[102:103], v197 offset:28672
    v_exp_f32 v188, v188
    v_fma_f32 v190, v190, s28, -v216
    v_mfma_f32_16x16x32_bf16 v[148:151], a[84:87], a[36:39], v[148:151]
    v_exp_f32 v189, v189
    v_mfma_f32_16x16x32_bf16 v[148:151], a[88:91], a[40:43], v[148:151]
    buffer_store_dwordx4 a[204:207], v212, s[16:19], s44 offen offset:128 sc1
    v_fma_f32 v191, v191, s28, -v216
    v_cvt_pk_bf16_f32 v173, v186, v187
    v_mfma_f32_16x16x32_bf16 v[148:151], a[92:95], a[44:47], v[148:151]
    ds_read_b64_tr_b16 a[104:105], v198 offset:24576
    v_exp_f32 v190, v190
    v_mfma_f32_16x16x32_bf16 v[156:159], a[80:83], a[48:51], 0
    ds_read_b64_tr_b16 a[106:107], v198 offset:28672
    v_exp_f32 v191, v191
    v_cvt_pk_bf16_f32 v174, v188, v189
    v_mfma_f32_16x16x32_bf16 v[156:159], a[84:87], a[52:55], v[156:159]
    v_cvt_pk_bf16_f32 v175, v190, v191
    v_mfma_f32_16x16x32_bf16 v[156:159], a[88:91], a[56:59], v[156:159]
    v_mfma_f32_16x16x32_bf16 v[156:159], a[92:95], a[60:63], v[156:159]
    s_waitcnt lgkmcnt(4)
    v_mfma_f32_16x16x32_bf16 v[0:3], a[96:99], v[160:163], v[0:3]
    ds_read_b64_tr_b16 a[108:109], v199 offset:24576
    v_mfma_f32_16x16x32_bf16 v[4:7], a[96:99], v[164:167], v[4:7]
    ds_read_b64_tr_b16 a[110:111], v199 offset:28672
    v_mfma_f32_16x16x32_bf16 a[132:135], a[128:131], v[160:163], a[132:135]
    v_max3_f32 v229, v128, v129, v130
    v_max3_f32 v230, v136, v137, v138
    v_mfma_f32_16x16x32_bf16 v[8:11], a[96:99], v[168:171], v[8:11]
    v_max3_f32 v231, v144, v145, v146
    v_max3_f32 v232, v152, v153, v154
    v_mfma_f32_16x16x32_bf16 v[12:15], a[96:99], v[172:175], v[12:15]
    s_waitcnt lgkmcnt(4)
    ds_read_b64_tr_b16 a[112:113], v200 offset:24576
    v_max3_f32 v229, v229, v131, v132
    v_max3_f32 v230, v230, v139, v140
    v_mfma_f32_16x16x32_bf16 v[16:19], a[100:103], v[160:163], v[16:19]
    ds_read_b64_tr_b16 a[114:115], v200 offset:28672
    v_max3_f32 v231, v231, v147, v148
    v_max3_f32 v232, v232, v155, v156
    v_mfma_f32_16x16x32_bf16 v[20:23], a[100:103], v[164:167], v[20:23]
    v_max3_f32 v229, v229, v133, v134
    v_max3_f32 v230, v230, v141, v142
    v_mfma_f32_16x16x32_bf16 v[24:27], a[100:103], v[168:171], v[24:27]
    v_max3_f32 v231, v231, v149, v150
    v_max3_f32 v232, v232, v157, v158
    v_mfma_f32_16x16x32_bf16 v[28:31], a[100:103], v[172:175], v[28:31]
    s_waitcnt lgkmcnt(4)
    v_max_f32 v229, v229, v135
    v_max_f32 v230, v230, v143
    v_mfma_f32_16x16x32_bf16 v[32:35], a[104:107], v[160:163], v[32:35]
    ds_read_b64_tr_b16 a[116:117], v201 offset:24576
    v_max_f32 v231, v231, v151
    v_max_f32 v232, v232, v159
    v_mfma_f32_16x16x32_bf16 v[36:39], a[104:107], v[164:167], v[36:39]
    ds_read_b64_tr_b16 a[118:119], v201 offset:28672
    v_mfma_f32_16x16x32_bf16 a[136:139], a[128:131], v[164:167], a[136:139]
    v_cmp_gt_f32 s[32:33], v229, v217
    v_cmp_gt_f32 s[34:35], v230, v218
    v_mfma_f32_16x16x32_bf16 v[40:43], a[104:107], v[168:171], v[40:43]
    v_cmp_gt_f32 s[36:37], v231, v219
    v_cmp_gt_f32 s[38:39], v232, v220
    v_mfma_f32_16x16x32_bf16 v[44:47], a[104:107], v[172:175], v[44:47]
    s_waitcnt lgkmcnt(4)
    ds_read_b64_tr_b16 a[120:121], v202 offset:24576
    s_or_b64 s[32:33], s[32:33], s[34:35]
    s_or_b64 s[36:37], s[36:37], s[38:39]
    v_mfma_f32_16x16x32_bf16 v[48:51], a[108:111], v[160:163], v[48:51]
    ds_read_b64_tr_b16 a[122:123], v202 offset:28672
    s_or_b64 s[32:33], s[32:33], s[36:37]
    s_cbranch_scc1 L_rb5
L_rbr5:
    v_mfma_f32_16x16x32_bf16 v[52:55], a[108:111], v[164:167], v[52:55]
    v_fma_f32 v128, v128, s28, -v213
    v_fma_f32 v129, v129, s28, -v213
    v_mfma_f32_16x16x32_bf16 v[56:59], a[108:111], v[168:171], v[56:59]
    v_exp_f32 v128, v128
    v_fma_f32 v130, v130, s28, -v213
    v_mfma_f32_16x16x32_bf16 v[60:63], a[108:111], v[172:175], v[60:63]
    s_waitcnt lgkmcnt(4)
    v_exp_f32 v129, v129
    v_mfma_f32_16x16x32_bf16 v[64:67], a[112:115], v[160:163], v[64:67]
    ds_read_b128 a[64:67], v192 offset:40960
    ds_read_b64_tr_b16 a[124:125], v203 offset:24576
    buffer_store_dwordx4 a[208:211], v212, s[16:19], s44 offen offset:2176 sc1
    v_fma_f32 v131, v131, s28, -v213
    v_exp_f32 v130, v130
    v_mfma_f32_16x16x32_bf16 v[68:71], a[112:115], v[164:167], v[68:71]
    ds_read_b128 a[68:71], v193 offset:40960
    ds_read_b64_tr_b16 a[126:127], v203 offset:28672
    v_fma_f32 v132, v132, s28, -v213
    v_mfma_f32_16x16x32_bf16 a[140:143], a[128:131], v[168:171], a[140:143]
    ds_read_b128 a[72:75], v194 offset:40960
    v_exp_f32 v131, v131
    v_fma_f32 v133, v133, s28, -v213
    v_mfma_f32_16x16x32_bf16 v[72:75], a[112:115], v[168:171], v[72:75]
    ds_read_b128 a[76:79], v195 offset:40960
    v_cvt_pk_bf16_f32 v128, v128, v129
    v_mfma_f32_16x16x32_bf16 v[76:79], a[112:115], v[172:175], v[76:79]
    s_waitcnt lgkmcnt(8)
    v_exp_f32 v132, v132
    v_fma_f32 v134, v134, s28, -v213
    v_mfma_f32_16x16x32_bf16 v[80:83], a[116:119], v[160:163], v[80:83]
    v_exp_f32 v133, v133
    v_fma_f32 v135, v135, s28, -v213
    v_mfma_f32_16x16x32_bf16 v[84:87], a[116:119], v[164:167], v[84:87]
    v_cvt_pk_bf16_f32 v129, v130, v131
    v_mfma_f32_16x16x32_bf16 v[88:91], a[116:119], v[168:171], v[88:91]
    v_exp_f32 v134, v134
    v_fma_f32 v136, v136, s28, -v214
    v_mfma_f32_16x16x32_bf16 v[92:95], a[116:119], v[172:175], v[92:95]
    s_waitcnt vmcnt(31) lgkmcnt(0)
    s_barrier
    v_exp_f32 v135, v135
    v_mfma_f32_16x16x32_bf16 v[96:99], a[120:123], v[160:163], v[96:99]
    v_fma_f32 v137, v137, s28, -v214
    v_cvt_pk_bf16_f32 v130, v132, v133
    v_mfma_f32_16x16x32_bf16 v[100:103], a[120:123], v[164:167], v[100:103]
    v_exp_f32 v136, v136
    v_mfma_f32_16x16x32_bf16 a[144:147], a[128:131], v[172:175], a[144:147]
    v_fma_f32 v138, v138, s28, -v214
    v_exp_f32 v137, v137
    v_mfma_f32_16x16x32_bf16 v[104:107], a[120:123], v[168:171], v[104:107]
    s_xor_b32 m0, s24, 0x4000
    s_add_u32 s23, s21, 0x0
    buffer_load_dwordx4 v208, s[80:83], s23 offen nt lds
    v_fma_f32 v139, v139, s28, -v214
    v_cvt_pk_bf16_f32 v131, v134, v135
    v_mfma_f32_16x16x32_bf16 v[108:111], a[120:123], v[172:175], v[108:111]
    v_exp_f32 v138, v138
    v_mfma_f32_16x16x32_bf16 v[112:115], a[124:127], v[160:163], v[112:115]
    buffer_load_dwordx4 v209, s[80:83], s23 offen offset:1024 nt lds
    v_fma_f32 v140, v140, s28, -v214
    v_exp_f32 v139, v139
    v_mfma_f32_16x16x32_bf16 v[116:119], a[124:127], v[164:167], v[116:119]
    v_fma_f32 v141, v141, s28, -v214
    v_mfma_f32_16x16x32_bf16 v[120:123], a[124:127], v[168:171], v[120:123]
    buffer_load_dwordx4 v208, s[80:83], s23 offen offset:2048 nt lds
    v_cvt_pk_bf16_f32 v132, v136, v137
    v_exp_f32 v140, v140
    v_mfma_f32_16x16x32_bf16 v[124:127], a[124:127], v[172:175], v[124:127]
    s_cmp_lg_u32 s27, 0
    s_cbranch_scc1 L_rc5
L_rcr5:
    v_fma_f32 v142, v142, s28, -v214
    v_mfma_f32_16x16x32_bf16 v[160:163], a[64:67], a[0:3], 0
    buffer_load_dwordx4 v209, s[80:83], s23 offen offset:3072 nt lds
    v_exp_f32 v141, v141
    v_fma_f32 v143, v143, s28, -v214
    v_mfma_f32_16x16x32_bf16 v[160:163], a[68:71], a[4:7], v[160:163]
    v_cvt_pk_bf16_f32 v133, v138, v139
    v_exp_f32 v142, v142
    v_mfma_f32_16x16x32_bf16 v[160:163], a[72:75], a[8:11], v[160:163]
    ds_read_b128 a[80:83], v192 offset:45056
    v_fma_f32 v144, v144, s28, -v215
    v_mfma_f32_16x16x32_bf16 v[160:163], a[76:79], a[12:15], v[160:163]
    ds_read_b128 a[84:87], v193 offset:45056
    v_exp_f32 v143, v143
    v_fma_f32 v145, v145, s28, -v215
    v_mfma_f32_16x16x32_bf16 v[168:171], a[64:67], a[16:19], 0
    ds_read_b128 a[88:91], v194 offset:45056
    v_cvt_pk_bf16_f32 v134, v140, v141
    v_mfma_f32_16x16x32_bf16 v[168:171], a[68:71], a[20:23], v[168:171]
    ds_read_b128 a[92:95], v195 offset:45056
    v_exp_f32 v144, v144
    v_fma_f32 v146, v146, s28, -v215
    v_mfma_f32_16x16x32_bf16 v[168:171], a[72:75], a[24:27], v[168:171]
    v_exp_f32 v145, v145
    v_mfma_f32_16x16x32_bf16 v[168:171], a[76:79], a[28:31], v[168:171]
    v_fma_f32 v147, v147, s28, -v215
    v_cvt_pk_bf16_f32 v135, v142, v143
    v_mfma_f32_16x16x32_bf16 v[176:179], a[64:67], a[32:35], 0
    v_exp_f32 v146, v146
    v_fma_f32 v148, v148, s28, -v215
    v_mfma_f32_16x16x32_bf16 v[176:179], a[68:71], a[36:39], v[176:179]
    v_exp_f32 v147, v147
    v_mfma_f32_16x16x32_bf16 v[176:179], a[72:75], a[40:43], v[176:179]
    v_fma_f32 v149, v149, s28, -v215
    v_cvt_pk_bf16_f32 v136, v144, v145
    v_mfma_f32_16x16x32_bf16 v[176:179], a[76:79], a[44:47], v[176:179]
    v_exp_f32 v148, v148
    v_mfma_f32_16x16x32_bf16 v[184:187], a[64:67], a[48:51], 0
    s_mov_b32 s22, s20
    v_fma_f32 v150, v150, s28, -v215
    v_exp_f32 v149, v149
    v_mfma_f32_16x16x32_bf16 v[184:187], a[68:71], a[52:55], v[184:187]
    s_add_u32 s29, s20, 0x1000
    v_fma_f32 v151, v151, s28, -v215
    v_mfma_f32_16x16x32_bf16 v[184:187], a[72:75], a[56:59], v[184:187]
    s_add_u32 s31, s20, 0x2000
    v_cvt_pk_bf16_f32 v137, v146, v147
    v_exp_f32 v150, v150
    v_mfma_f32_16x16x32_bf16 v[184:187], a[76:79], a[60:63], v[184:187]
    s_waitcnt lgkmcnt(3)
    s_add_u32 s44, s20, 0x3000
    v_fma_f32 v152, v152, s28, -v216
    v_exp_f32 v151, v151
    v_mfma_f32_16x16x32_bf16 v[164:167], a[80:83], a[0:3], 0
    s_waitcnt lgkmcnt(2)
    s_mov_b32 s20, s21
    v_fma_f32 v153, v153, s28, -v216
    v_mfma_f32_16x16x32_bf16 v[164:167], a[84:87], a[4:7], v[164:167]
    s_waitcnt lgkmcnt(1)
    s_add_u32 s21, s21, 0x1000000
    v_cvt_pk_bf16_f32 v138, v148, v149
    v_exp_f32 v152, v152
    v_mfma_f32_16x16x32_bf16 v[164:167], a[88:91], a[8:11], v[164:167]
    s_waitcnt lgkmcnt(0)
    ds_read_b64_tr_b16 a[96:97], v196 offset:49152
    s_xor_b32 s24, s24, 0x10000
    v_fma_f32 v154, v154, s28, -v216
    v_mfma_f32_16x16x32_bf16 v[164:167], a[92:95], a[12:15], v[164:167]
    ds_read_b64_tr_b16 a[98:99], v196 offset:53248
    s_sub_u32 s26, s26, 1
    v_exp_f32 v153, v153
    v_fma_f32 v155, v155, s28, -v216
    v_mfma_f32_16x16x32_bf16 v[172:175], a[80:83], a[16:19], 0
    s_mov_b32 s18, 0x8000000
    v_cvt_pk_bf16_f32 v139, v150, v151
    v_mfma_f32_16x16x32_bf16 v[172:175], a[84:87], a[20:23], v[172:175]
    v_exp_f32 v154, v154
    v_fma_f32 v156, v156, s28, -v216
    v_mfma_f32_16x16x32_bf16 v[172:175], a[88:91], a[24:27], v[172:175]
    v_exp_f32 v155, v155
    v_fma_f32 v157, v157, s28, -v216
    v_mfma_f32_16x16x32_bf16 v[172:175], a[92:95], a[28:31], v[172:175]
    ds_read_b64_tr_b16 a[100:101], v197 offset:49152
    v_cvt_pk_bf16_f32 v140, v152, v153
    v_mfma_f32_16x16x32_bf16 v[180:183], a[80:83], a[32:35], 0
    ds_read_b64_tr_b16 a[102:103], v197 offset:53248
    v_exp_f32 v156, v156
    v_fma_f32 v158, v158, s28, -v216
    v_mfma_f32_16x16x32_bf16 v[180:183], a[84:87], a[36:39], v[180:183]
    v_exp_f32 v157, v157
    v_mfma_f32_16x16x32_bf16 v[180:183], a[88:91], a[40:43], v[180:183]
    v_fma_f32 v159, v159, s28, -v216
    v_cvt_pk_bf16_f32 v141, v154, v155
    v_mfma_f32_16x16x32_bf16 v[180:183], a[92:95], a[44:47], v[180:183]
    ds_read_b64_tr_b16 a[104:105], v198 offset:49152
    v_exp_f32 v158, v158
    v_mfma_f32_16x16x32_bf16 v[188:191], a[80:83], a[48:51], 0
    ds_read_b64_tr_b16 a[106:107], v198 offset:53248
    v_exp_f32 v159, v159
    v_cvt_pk_bf16_f32 v142, v156, v157
    v_mfma_f32_16x16x32_bf16 v[188:191], a[84:87], a[52:55], v[188:191]
    v_cvt_pk_bf16_f32 v143, v158, v159
    v_mfma_f32_16x16x32_bf16 v[188:191], a[88:91], a[56:59], v[188:191]
    v_mfma_f32_16x16x32_bf16 v[188:191], a[92:95], a[60:63], v[188:191]
    s_waitcnt lgkmcnt(4)
    v_mfma_f32_16x16x32_bf16 v[0:3], a[96:99], v[128:131], v[0:3]
    ds_read_b64_tr_b16 a[108:109], v199 offset:49152
    v_mfma_f32_16x16x32_bf16 v[4:7], a[96:99], v[132:135], v[4:7]
    ds_read_b64_tr_b16 a[110:111], v199 offset:53248
    v_mfma_f32_16x16x32_bf16 a[132:135], a[128:131], v[128:131], a[132:135]
    v_mfma_f32_16x16x32_bf16 v[8:11], a[96:99], v[136:139], v[8:11]
    v_mfma_f32_16x16x32_bf16 v[12:15], a[96:99], v[140:143], v[12:15]
    ds_read_b64_tr_b16 a[112:113], v200 offset:49152
    s_cmp_lg_u32 s26, 0
    s_cbranch_scc1 L_loop
    s_waitcnt vmcnt(30) lgkmcnt(0)
    v_mfma_f32_16x16x32_bf16 v[16:19], a[100:103], v[128:131], v[16:19]
    ds_read_b64_tr_b16 a[114:115], v200 offset:53248
    v_max3_f32 v229, v160, v161, v162
    v_max3_f32 v230, v168, v169, v170
    v_max3_f32 v231, v176, v177, v178
    v_mfma_f32_16x16x32_bf16 v[20:23], a[100:103], v[132:135], v[20:23]
    v_max3_f32 v232, v184, v185, v186
    v_max3_f32 v229, v229, v163, v164
    v_max3_f32 v230, v230, v171, v172
    v_mfma_f32_16x16x32_bf16 v[24:27], a[100:103], v[136:139], v[24:27]
    v_max3_f32 v231, v231, v179, v180
    v_max3_f32 v232, v232, v187, v188
    v_mfma_f32_16x16x32_bf16 v[28:31], a[100:103], v[140:143], v[28:31]
    v_max3_f32 v229, v229, v165, v166
    v_max3_f32 v230, v230, v173, v174
    v_max3_f32 v231, v231, v181, v182
    v_mfma_f32_16x16x32_bf16 v[32:35], a[104:107], v[128:131], v[32:35]
    ds_read_b64_tr_b16 a[116:117], v201 offset:49152
    v_max3_f32 v232, v232, v189, v190
    v_max_f32 v229, v229, v167
    v_max_f32 v230, v230, v175
    v_mfma_f32_16x16x32_bf16 v[36:39], a[104:107], v[132:135], v[36:39]
    ds_read_b64_tr_b16 a[118:119], v201 offset:53248
    v_max_f32 v231, v231, v183
    v_max_f32 v232, v232, v191
    v_mfma_f32_16x16x32_bf16 a[136:139], a[128:131], v[132:135], a[136:139]
    v_cmp_gt_f32 s[32:33], v229, v217
    v_cmp_gt_f32 s[34:35], v230, v218
    v_mfma_f32_16x16x32_bf16 v[40:43], a[104:107], v[136:139], v[40:43]
    v_cmp_gt_f32 s[36:37], v231, v219
    v_cmp_gt_f32 s[38:39], v232, v220
    v_mfma_f32_16x16x32_bf16 v[44:47], a[104:107], v[140:143], v[44:47]
    ds_read_b64_tr_b16 a[120:121], v202 offset:49152
    s_or_b64 s[32:33], s[32:33], s[34:35]
    s_nop 0
    s_or_b64 s[36:37], s[36:37], s[38:39]
    v_mfma_f32_16x16x32_bf16 v[48:51], a[108:111], v[128:131], v[48:51]
    ds_read_b64_tr_b16 a[122:123], v202 offset:53248
    s_or_b64 s[32:33], s[32:33], s[36:37]
    s_cbranch_scc1 L_rb7
L_rbr7:
    v_mfma_f32_16x16x32_bf16 v[52:55], a[108:111], v[132:135], v[52:55]
    v_fma_f32 v160, v160, s28, -v213
    v_fma_f32 v161, v161, s28, -v213
    v_mfma_f32_16x16x32_bf16 v[56:59], a[108:111], v[136:139], v[56:59]
    v_exp_f32 v160, v160
    v_fma_f32 v162, v162, s28, -v213
    v_mfma_f32_16x16x32_bf16 v[60:63], a[108:111], v[140:143], v[60:63]
    s_waitcnt lgkmcnt(4)
    v_exp_f32 v161, v161
    v_mfma_f32_16x16x32_bf16 v[64:67], a[112:115], v[128:131], v[64:67]
    ds_read_b64_tr_b16 a[124:125], v203 offset:49152
    v_fma_f32 v163, v163, s28, -v213
    v_exp_f32 v162, v162
    v_mfma_f32_16x16x32_bf16 v[68:71], a[112:115], v[132:135], v[68:71]
    ds_read_b64_tr_b16 a[126:127], v203 offset:53248
    v_fma_f32 v164, v164, s28, -v213
    v_mfma_f32_16x16x32_bf16 a[140:143], a[128:131], v[136:139], a[140:143]
    v_exp_f32 v163, v163
    v_fma_f32 v165, v165, s28, -v213
    v_mfma_f32_16x16x32_bf16 v[72:75], a[112:115], v[136:139], v[72:75]
    v_cvt_pk_bf16_f32 v160, v160, v161
    v_mfma_f32_16x16x32_bf16 v[76:79], a[112:115], v[140:143], v[76:79]
    s_waitcnt lgkmcnt(4)
    v_exp_f32 v164, v164
    v_fma_f32 v166, v166, s28, -v213
    v_mfma_f32_16x16x32_bf16 v[80:83], a[116:119], v[128:131], v[80:83]
    v_exp_f32 v165, v165
    v_fma_f32 v167, v167, s28, -v213
    v_mfma_f32_16x16x32_bf16 v[84:87], a[116:119], v[132:135], v[84:87]
    v_cvt_pk_bf16_f32 v161, v162, v163
    v_mfma_f32_16x16x32_bf16 v[88:91], a[116:119], v[136:139], v[88:91]
    v_exp_f32 v166, v166
    v_fma_f32 v168, v168, s28, -v214
    v_mfma_f32_16x16x32_bf16 v[92:95], a[116:119], v[140:143], v[92:95]
    s_waitcnt lgkmcnt(2)
    v_exp_f32 v167, v167
    v_mfma_f32_16x16x32_bf16 v[96:99], a[120:123], v[128:131], v[96:99]
    v_fma_f32 v169, v169, s28, -v214
    v_cvt_pk_bf16_f32 v162, v164, v165
    v_mfma_f32_16x16x32_bf16 v[100:103], a[120:123], v[132:135], v[100:103]
    v_exp_f32 v168, v168
    v_mfma_f32_16x16x32_bf16 a[144:147], a[128:131], v[140:143], a[144:147]
    v_fma_f32 v170, v170, s28, -v214
    v_exp_f32 v169, v169
    v_mfma_f32_16x16x32_bf16 v[104:107], a[120:123], v[136:139], v[104:107]
    v_fma_f32 v171, v171, s28, -v214
    v_cvt_pk_bf16_f32 v163, v166, v167
    v_mfma_f32_16x16x32_bf16 v[108:111], a[120:123], v[140:143], v[108:111]
    s_waitcnt lgkmcnt(0)
    v_exp_f32 v170, v170
    v_mfma_f32_16x16x32_bf16 v[112:115], a[124:127], v[128:131], v[112:115]
    v_fma_f32 v172, v172, s28, -v214
    v_exp_f32 v171, v171
    v_mfma_f32_16x16x32_bf16 v[116:119], a[124:127], v[132:135], v[116:119]
    v_fma_f32 v173, v173, s28, -v214
    v_mfma_f32_16x16x32_bf16 v[120:123], a[124:127], v[136:139], v[120:123]
    v_cvt_pk_bf16_f32 v164, v168, v169
    v_exp_f32 v172, v172
    v_mfma_f32_16x16x32_bf16 v[124:127], a[124:127], v[140:143], v[124:127]
    s_cmp_lg_u32 s27, 0
    s_cbranch_scc1 L_rc7
L_rcr7:
    v_fma_f32 v174, v174, s28, -v214
    v_exp_f32 v173, v173
    v_fma_f32 v175, v175, s28, -v214
    v_cvt_pk_bf16_f32 v165, v170, v171
    v_exp_f32 v174, v174
    v_fma_f32 v176, v176, s28, -v215
    v_exp_f32 v175, v175
    v_fma_f32 v177, v177, s28, -v215
    v_cvt_pk_bf16_f32 v166, v172, v173
    v_exp_f32 v176, v176
    v_fma_f32 v178, v178, s28, -v215
    v_exp_f32 v177, v177
    v_fma_f32 v179, v179, s28, -v215
    v_cvt_pk_bf16_f32 v167, v174, v175
    v_exp_f32 v178, v178
    v_fma_f32 v180, v180, s28, -v215
    v_exp_f32 v179, v179
    v_fma_f32 v181, v181, s28, -v215
    v_cvt_pk_bf16_f32 v168, v176, v177
    v_exp_f32 v180, v180
    v_fma_f32 v182, v182, s28, -v215
    v_exp_f32 v181, v181
    v_fma_f32 v183, v183, s28, -v215
    v_cvt_pk_bf16_f32 v169, v178, v179
    v_exp_f32 v182, v182
    v_fma_f32 v184, v184, s28, -v216
    v_exp_f32 v183, v183
    v_fma_f32 v185, v185, s28, -v216
    v_cvt_pk_bf16_f32 v170, v180, v181
    v_exp_f32 v184, v184
    v_fma_f32 v186, v186, s28, -v216
    v_exp_f32 v185, v185
    v_fma_f32 v187, v187, s28, -v216
    v_cvt_pk_bf16_f32 v171, v182, v183
    v_exp_f32 v186, v186
    v_fma_f32 v188, v188, s28, -v216
    ds_read_b64_tr_b16 a[96:97], v196 offset:57344
    v_exp_f32 v187, v187
    v_fma_f32 v189, v189, s28, -v216
    ds_read_b64_tr_b16 a[98:99], v196 offset:61440
    v_cvt_pk_bf16_f32 v172, v184, v185
    v_exp_f32 v188, v188
    v_fma_f32 v190, v190, s28, -v216
    v_exp_f32 v189, v189
    ds_read_b64_tr_b16 a[100:101], v197 offset:57344
    v_fma_f32 v191, v191, s28, -v216
    v_cvt_pk_bf16_f32 v173, v186, v187
    ds_read_b64_tr_b16 a[102:103], v197 offset:61440
    v_exp_f32 v190, v190
    v_exp_f32 v191, v191
    v_cvt_pk_bf16_f32 v174, v188, v189
    v_cvt_pk_bf16_f32 v175, v190, v191
    ds_read_b64_tr_b16 a[104:105], v198 offset:57344
    ds_read_b64_tr_b16 a[106:107], v198 offset:61440
    v_mfma_f32_16x16x32_bf16 a[132:135], a[128:131], v[160:163], a[132:135]
    v_mfma_f32_16x16x32_bf16 a[136:139], a[128:131], v[164:167], a[136:139]
    v_mfma_f32_16x16x32_bf16 a[140:143], a[128:131], v[168:171], a[140:143]
    ds_read_b64_tr_b16 a[108:109], v199 offset:57344
    v_mfma_f32_16x16x32_bf16 a[144:147], a[128:131], v[172:175], a[144:147]
    s_waitcnt lgkmcnt(5)
    ds_read_b64_tr_b16 a[110:111], v199 offset:61440
    v_mfma_f32_16x16x32_bf16 v[0:3], a[96:99], v[160:163], v[0:3]
    v_mfma_f32_16x16x32_bf16 v[4:7], a[96:99], v[164:167], v[4:7]
    v_mfma_f32_16x16x32_bf16 v[8:11], a[96:99], v[168:171], v[8:11]
    ds_read_b64_tr_b16 a[112:113], v200 offset:57344
    v_mfma_f32_16x16x32_bf16 v[12:15], a[96:99], v[172:175], v[12:15]
    s_waitcnt lgkmcnt(5)
    ds_read_b64_tr_b16 a[114:115], v200 offset:61440
    v_mfma_f32_16x16x32_bf16 v[16:19], a[100:103], v[160:163], v[16:19]
    v_accvgpr_read_b32 v222, a132
    v_accvgpr_read_b32 v224, a136
    v_mfma_f32_16x16x32_bf16 v[20:23], a[100:103], v[164:167], v[20:23]
    v_accvgpr_read_b32 v226, a140
    v_accvgpr_read_b32 v228, a144
    v_mfma_f32_16x16x32_bf16 v[24:27], a[100:103], v[168:171], v[24:27]
    ds_read_b64_tr_b16 a[116:117], v201 offset:57344
    v_rcp_f32 v222, v222
    v_rcp_f32 v224, v224
    v_mfma_f32_16x16x32_bf16 v[28:31], a[100:103], v[172:175], v[28:31]
    s_waitcnt lgkmcnt(5)
    ds_read_b64_tr_b16 a[118:119], v201 offset:61440
    v_rcp_f32 v226, v226
    v_rcp_f32 v228, v228
    v_mfma_f32_16x16x32_bf16 v[32:35], a[104:107], v[160:163], v[32:35]
    v_xor_b32 v237, 0x0, v210
    v_mul_f32 v0, v0, v222
    v_mul_f32 v1, v1, v222
    v_mfma_f32_16x16x32_bf16 v[36:39], a[104:107], v[164:167], v[36:39]
    v_mul_f32 v2, v2, v222
    v_mul_f32 v3, v3, v222
    v_cvt_pk_bf16_f32 v0, v0, v1
    v_mfma_f32_16x16x32_bf16 v[40:43], a[104:107], v[168:171], v[40:43]
    ds_read_b64_tr_b16 a[120:121], v202 offset:57344
    v_cvt_pk_bf16_f32 v1, v2, v3
    v_mul_f32 v4, v4, v224
    v_mfma_f32_16x16x32_bf16 v[44:47], a[104:107], v[172:175], v[44:47]
    s_waitcnt lgkmcnt(5)
    ds_read_b64_tr_b16 a[122:123], v202 offset:61440
    ds_write_b64 v237, v[0:1] offset:0
    v_mul_f32 v5, v5, v224
    v_mul_f32 v6, v6, v224
    v_mul_f32 v7, v7, v224
    v_mfma_f32_16x16x32_bf16 v[48:51], a[108:111], v[160:163], v[48:51]
    v_cvt_pk_bf16_f32 v4, v4, v5
    v_cvt_pk_bf16_f32 v5, v6, v7
    v_mfma_f32_16x16x32_bf16 v[52:55], a[108:111], v[164:167], v[52:55]
    v_mul_f32 v8, v8, v226
    v_mul_f32 v9, v9, v226
    v_mfma_f32_16x16x32_bf16 v[56:59], a[108:111], v[168:171], v[56:59]
    ds_read_b64_tr_b16 a[124:125], v203 offset:57344
    ds_write_b64 v237, v[4:5] offset:2048
    v_mul_f32 v10, v10, v226
    v_mul_f32 v11, v11, v226
    v_cvt_pk_bf16_f32 v8, v8, v9
    v_mfma_f32_16x16x32_bf16 v[60:63], a[108:111], v[172:175], v[60:63]
    s_waitcnt lgkmcnt(7)
    ds_read_b64_tr_b16 a[126:127], v203 offset:61440
    v_cvt_pk_bf16_f32 v9, v10, v11
    v_mul_f32 v12, v12, v228
    v_mfma_f32_16x16x32_bf16 v[64:67], a[112:115], v[160:163], v[64:67]
    ds_write_b64 v237, v[8:9] offset:4096
    v_mul_f32 v13, v13, v228
    v_mul_f32 v14, v14, v228
    v_mfma_f32_16x16x32_bf16 v[68:71], a[112:115], v[164:167], v[68:71]
    v_mul_f32 v15, v15, v228
    v_cvt_pk_bf16_f32 v12, v12, v13
    v_cvt_pk_bf16_f32 v13, v14, v15
    v_mfma_f32_16x16x32_bf16 v[72:75], a[112:115], v[168:171], v[72:75]
    v_xor_b32 v238, 0x20, v210
    v_mul_f32 v16, v16, v222
    v_mfma_f32_16x16x32_bf16 v[76:79], a[112:115], v[172:175], v[76:79]
    s_waitcnt lgkmcnt(7)
    ds_write_b64 v237, v[12:13] offset:6144
    v_mul_f32 v17, v17, v222
    v_mul_f32 v18, v18, v222
    v_mul_f32 v19, v19, v222
    v_mfma_f32_16x16x32_bf16 v[80:83], a[116:119], v[160:163], v[80:83]
    v_cvt_pk_bf16_f32 v16, v16, v17
    v_cvt_pk_bf16_f32 v17, v18, v19
    v_mfma_f32_16x16x32_bf16 v[84:87], a[116:119], v[164:167], v[84:87]
    v_mul_f32 v20, v20, v224
    v_mul_f32 v21, v21, v224
    v_mfma_f32_16x16x32_bf16 v[88:91], a[116:119], v[168:171], v[88:91]
    ds_write_b64 v238, v[16:17] offset:0
    v_mul_f32 v22, v22, v224
    v_mul_f32 v23, v23, v224
    v_cvt_pk_bf16_f32 v20, v20, v21
    v_mfma_f32_16x16x32_bf16 v[92:95], a[116:119], v[172:175], v[92:95]
    s_waitcnt lgkmcnt(7)
    v_cvt_pk_bf16_f32 v21, v22, v23
    v_mul_f32 v24, v24, v226
    v_mfma_f32_16x16x32_bf16 v[96:99], a[120:123], v[160:163], v[96:99]
    ds_write_b64 v238, v[20:21] offset:2048
    v_mul_f32 v25, v25, v226
    v_mul_f32 v26, v26, v226
    v_mfma_f32_16x16x32_bf16 v[100:103], a[120:123], v[164:167], v[100:103]
    v_mul_f32 v27, v27, v226
    v_cvt_pk_bf16_f32 v24, v24, v25
    v_cvt_pk_bf16_f32 v25, v26, v27
    v_mfma_f32_16x16x32_bf16 v[104:107], a[120:123], v[168:171], v[104:107]
    v_mul_f32 v28, v28, v228
    v_mul_f32 v29, v29, v228
    v_mfma_f32_16x16x32_bf16 v[108:111], a[120:123], v[172:175], v[108:111]
    s_waitcnt lgkmcnt(4)
    ds_write_b64 v238, v[24:25] offset:4096
    v_mul_f32 v30, v30, v228
    v_mul_f32 v31, v31, v228
    v_cvt_pk_bf16_f32 v28, v28, v29
    v_mfma_f32_16x16x32_bf16 v[112:115], a[124:127], v[160:163], v[112:115]
    v_cvt_pk_bf16_f32 v29, v30, v31
    v_mfma_f32_16x16x32_bf16 v[116:119], a[124:127], v[164:167], v[116:119]
    ds_write_b64 v238, v[28:29] offset:6144
    v_xor_b32 v237, 0x40, v210
    v_mul_f32 v32, v32, v222
    v_mul_f32 v33, v33, v222
    v_mfma_f32_16x16x32_bf16 v[120:123], a[124:127], v[168:171], v[120:123]
    v_mul_f32 v34, v34, v222
    v_mul_f32 v35, v35, v222
    v_cvt_pk_bf16_f32 v32, v32, v33
    v_mfma_f32_16x16x32_bf16 v[124:127], a[124:127], v[172:175], v[124:127]
    v_cvt_pk_bf16_f32 v33, v34, v35
    v_pk_mul_f32 v[36:37], v[36:37], v[224:225] op_sel_hi:[1,0]
    ds_write_b64 v237, v[32:33] offset:0
    v_pk_mul_f32 v[38:39], v[38:39], v[224:225] op_sel_hi:[1,0]
    v_cvt_pk_bf16_f32 v36, v36, v37
    v_cvt_pk_bf16_f32 v37, v38, v39
    v_pk_mul_f32 v[40:41], v[40:41], v[226:227] op_sel_hi:[1,0]
    ds_write_b64 v237, v[36:37] offset:2048
    v_pk_mul_f32 v[42:43], v[42:43], v[226:227] op_sel_hi:[1,0]
    v_cvt_pk_bf16_f32 v40, v40, v41
    v_cvt_pk_bf16_f32 v41, v42, v43
    v_pk_mul_f32 v[44:45], v[44:45], v[228:229] op_sel_hi:[1,0]
    ds_write_b64 v237, v[40:41] offset:4096
    v_pk_mul_f32 v[46:47], v[46:47], v[228:229] op_sel_hi:[1,0]
    v_cvt_pk_bf16_f32 v44, v44, v45
    v_cvt_pk_bf16_f32 v45, v46, v47
    v_xor_b32 v238, 0x60, v210
    v_pk_mul_f32 v[48:49], v[48:49], v[222:223] op_sel_hi:[1,0]
    ds_write_b64 v237, v[44:45] offset:6144
    v_pk_mul_f32 v[50:51], v[50:51], v[222:223] op_sel_hi:[1,0]
    v_cvt_pk_bf16_f32 v48, v48, v49
    v_cvt_pk_bf16_f32 v49, v50, v51
    v_pk_mul_f32 v[52:53], v[52:53], v[224:225] op_sel_hi:[1,0]
    ds_write_b64 v238, v[48:49] offset:0
    v_pk_mul_f32 v[54:55], v[54:55], v[224:225] op_sel_hi:[1,0]
    v_cvt_pk_bf16_f32 v52, v52, v53
    v_cvt_pk_bf16_f32 v53, v54, v55
    v_pk_mul_f32 v[56:57], v[56:57], v[226:227] op_sel_hi:[1,0]
    ds_write_b64 v238, v[52:53] offset:2048
    v_pk_mul_f32 v[58:59], v[58:59], v[226:227] op_sel_hi:[1,0]
    v_cvt_pk_bf16_f32 v56, v56, v57
    v_cvt_pk_bf16_f32 v57, v58, v59
    v_pk_mul_f32 v[60:61], v[60:61], v[228:229] op_sel_hi:[1,0]
    ds_write_b64 v238, v[56:57] offset:4096
    v_pk_mul_f32 v[62:63], v[62:63], v[228:229] op_sel_hi:[1,0]
    v_cvt_pk_bf16_f32 v60, v60, v61
    v_cvt_pk_bf16_f32 v61, v62, v63
    ds_write_b64 v238, v[60:61] offset:6144
    ds_read_b128 a[148:151], v211 offset:0
    s_waitcnt lgkmcnt(14)
    ds_read_b128 a[152:155], v211 offset:1024
    s_waitcnt lgkmcnt(14)
    ds_read_b128 a[156:159], v211 offset:2048
    s_waitcnt lgkmcnt(14)
    ds_read_b128 a[160:163], v211 offset:3072
    v_xor_b32 v237, 0x0, v210
    v_pk_mul_f32 v[64:65], v[64:65], v[222:223] op_sel_hi:[1,0]
    s_waitcnt lgkmcnt(14)
    ds_read_b128 a[164:167], v211 offset:4096
    s_waitcnt lgkmcnt(14)
    ds_read_b128 a[168:171], v211 offset:5120
    v_pk_mul_f32 v[66:67], v[66:67], v[222:223] op_sel_hi:[1,0]
    v_cvt_pk_bf16_f32 v64, v64, v65
    s_waitcnt lgkmcnt(14)
    ds_read_b128 a[172:175], v211 offset:6144
    s_waitcnt lgkmcnt(14)
    ds_read_b128 a[176:179], v211 offset:7168
    v_cvt_pk_bf16_f32 v65, v66, v67
    s_waitcnt lgkmcnt(14)
    ds_write_b64 v237, v[64:65] offset:0
    v_pk_mul_f32 v[68:69], v[68:69], v[224:225] op_sel_hi:[1,0]
    v_pk_mul_f32 v[70:71], v[70:71], v[224:225] op_sel_hi:[1,0]
    v_cvt_pk_bf16_f32 v68, v68, v69
    v_cvt_pk_bf16_f32 v69, v70, v71
    v_pk_mul_f32 v[72:73], v[72:73], v[226:227] op_sel_hi:[1,0]
    s_waitcnt lgkmcnt(14)
    ds_write_b64 v237, v[68:69] offset:2048
    v_pk_mul_f32 v[74:75], v[74:75], v[226:227] op_sel_hi:[1,0]
    v_cvt_pk_bf16_f32 v72, v72, v73
    v_cvt_pk_bf16_f32 v73, v74, v75
    s_waitcnt lgkmcnt(14)
    ds_write_b64 v237, v[72:73] offset:4096
    v_pk_mul_f32 v[76:77], v[76:77], v[228:229] op_sel_hi:[1,0]
    v_pk_mul_f32 v[78:79], v[78:79], v[228:229] op_sel_hi:[1,0]
    v_cvt_pk_bf16_f32 v76, v76, v77
    s_waitcnt lgkmcnt(10)
    buffer_store_dwordx4 a[148:151], v212, s[16:19], s22 offen offset:0 sc1
    v_cvt_pk_bf16_f32 v77, v78, v79
    ds_write_b64 v237, v[76:77] offset:6144
    v_xor_b32 v238, 0x20, v210
    v_pk_mul_f32 v[80:81], v[80:81], v[222:223] op_sel_hi:[1,0]
    v_pk_mul_f32 v[82:83], v[82:83], v[222:223] op_sel_hi:[1,0]
    v_cvt_pk_bf16_f32 v80, v80, v81
    v_cvt_pk_bf16_f32 v81, v82, v83
    ds_write_b64 v238, v[80:81] offset:0
    v_pk_mul_f32 v[84:85], v[84:85], v[224:225] op_sel_hi:[1,0]
    v_pk_mul_f32 v[86:87], v[86:87], v[224:225] op_sel_hi:[1,0]
    v_cvt_pk_bf16_f32 v84, v84, v85
    v_cvt_pk_bf16_f32 v85, v86, v87
    v_pk_mul_f32 v[88:89], v[88:89], v[226:227] op_sel_hi:[1,0]
    ds_write_b64 v238, v[84:85] offset:2048
    v_pk_mul_f32 v[90:91], v[90:91], v[226:227] op_sel_hi:[1,0]
    v_cvt_pk_bf16_f32 v88, v88, v89
    v_cvt_pk_bf16_f32 v89, v90, v91
    ds_write_b64 v238, v[88:89] offset:4096
    v_pk_mul_f32 v[92:93], v[92:93], v[228:229] op_sel_hi:[1,0]
    v_pk_mul_f32 v[94:95], v[94:95], v[228:229] op_sel_hi:[1,0]
    v_cvt_pk_bf16_f32 v92, v92, v93
    v_cvt_pk_bf16_f32 v93, v94, v95
    ds_write_b64 v238, v[92:93] offset:6144
    v_xor_b32 v237, 0x40, v210
    v_pk_mul_f32 v[96:97], v[96:97], v[222:223] op_sel_hi:[1,0]
    v_pk_mul_f32 v[98:99], v[98:99], v[222:223] op_sel_hi:[1,0]
    v_cvt_pk_bf16_f32 v96, v96, v97
    v_cvt_pk_bf16_f32 v97, v98, v99
    s_waitcnt lgkmcnt(14)
    ds_write_b64 v237, v[96:97] offset:0
    v_pk_mul_f32 v[100:101], v[100:101], v[224:225] op_sel_hi:[1,0]
    v_pk_mul_f32 v[102:103], v[102:103], v[224:225] op_sel_hi:[1,0]
    v_cvt_pk_bf16_f32 v100, v100, v101
    v_cvt_pk_bf16_f32 v101, v102, v103
    v_pk_mul_f32 v[104:105], v[104:105], v[226:227] op_sel_hi:[1,0]
    s_waitcnt lgkmcnt(14)
    ds_write_b64 v237, v[100:101] offset:2048
    v_pk_mul_f32 v[106:107], v[106:107], v[226:227] op_sel_hi:[1,0]
    v_cvt_pk_bf16_f32 v104, v104, v105
    v_cvt_pk_bf16_f32 v105, v106, v107
    s_waitcnt lgkmcnt(14)
    ds_write_b64 v237, v[104:105] offset:4096
    v_pk_mul_f32 v[108:109], v[108:109], v[228:229] op_sel_hi:[1,0]
    v_pk_mul_f32 v[110:111], v[110:111], v[228:229] op_sel_hi:[1,0]
    v_cvt_pk_bf16_f32 v108, v108, v109
    v_cvt_pk_bf16_f32 v109, v110, v111
    s_waitcnt lgkmcnt(14)
    ds_write_b64 v237, v[108:109] offset:6144
    v_xor_b32 v238, 0x60, v210
    v_pk_mul_f32 v[112:113], v[112:113], v[222:223] op_sel_hi:[1,0]
    buffer_store_dwordx4 a[152:155], v212, s[16:19], s22 offen offset:2048 sc1
    v_pk_mul_f32 v[114:115], v[114:115], v[222:223] op_sel_hi:[1,0]
    v_cvt_pk_bf16_f32 v112, v112, v113
    v_cvt_pk_bf16_f32 v113, v114, v115
    s_waitcnt lgkmcnt(14)
    ds_write_b64 v238, v[112:113] offset:0
    v_pk_mul_f32 v[116:117], v[116:117], v[224:225] op_sel_hi:[1,0]
    v_pk_mul_f32 v[118:119], v[118:119], v[224:225] op_sel_hi:[1,0]
    v_cvt_pk_bf16_f32 v116, v116, v117
    v_cvt_pk_bf16_f32 v117, v118, v119
    v_pk_mul_f32 v[120:121], v[120:121], v[226:227] op_sel_hi:[1,0]
    s_waitcnt lgkmcnt(14)
    ds_write_b64 v238, v[116:117] offset:2048
    v_pk_mul_f32 v[122:123], v[122:123], v[226:227] op_sel_hi:[1,0]
    v_cvt_pk_bf16_f32 v120, v120, v121
    v_cvt_pk_bf16_f32 v121, v122, v123
    s_waitcnt lgkmcnt(14)
    ds_write_b64 v238, v[120:121] offset:4096
    v_pk_mul_f32 v[124:125], v[124:125], v[228:229] op_sel_hi:[1,0]
    v_pk_mul_f32 v[126:127], v[126:127], v[228:229] op_sel_hi:[1,0]
    v_cvt_pk_bf16_f32 v124, v124, v125
    v_cvt_pk_bf16_f32 v125, v126, v127
    s_waitcnt lgkmcnt(14)
    ds_write_b64 v238, v[124:125] offset:6144
    s_waitcnt lgkmcnt(14)
    ds_read_b128 a[180:183], v211 offset:0
    s_waitcnt lgkmcnt(14)
    ds_read_b128 a[184:187], v211 offset:1024
    s_waitcnt lgkmcnt(14)
    ds_read_b128 a[188:191], v211 offset:2048
    s_waitcnt lgkmcnt(14)
    ds_read_b128 a[192:195], v211 offset:3072
    s_waitcnt lgkmcnt(14)
    ds_read_b128 a[196:199], v211 offset:4096
    s_waitcnt lgkmcnt(14)
    ds_read_b128 a[200:203], v211 offset:5120
    s_waitcnt lgkmcnt(14)
    ds_read_b128 a[204:207], v211 offset:6144
    s_waitcnt lgkmcnt(14)
    ds_read_b128 a[208:211], v211 offset:7168
    buffer_store_dwordx4 a[156:159], v212, s[16:19], s29 offen offset:0 sc1
    buffer_store_dwordx4 a[160:163], v212, s[16:19], s29 offen offset:2048 sc1
    buffer_store_dwordx4 a[164:167], v212, s[16:19], s31 offen offset:0 sc1
    buffer_store_dwordx4 a[168:171], v212, s[16:19], s31 offen offset:2048 sc1
    buffer_store_dwordx4 a[172:175], v212, s[16:19], s44 offen offset:0 sc1
    buffer_store_dwordx4 a[176:179], v212, s[16:19], s44 offen offset:2048 sc1
    s_waitcnt lgkmcnt(7)
    buffer_store_dwordx4 a[180:183], v212, s[16:19], s22 offen offset:128 sc1
    s_waitcnt lgkmcnt(6)
    buffer_store_dwordx4 a[184:187], v212, s[16:19], s22 offen offset:2176 sc1
    s_waitcnt lgkmcnt(5)
    buffer_store_dwordx4 a[188:191], v212, s[16:19], s29 offen offset:128 sc1
    s_waitcnt lgkmcnt(4)
    buffer_store_dwordx4 a[192:195], v212, s[16:19], s29 offen offset:2176 sc1
    s_waitcnt lgkmcnt(3)
    buffer_store_dwordx4 a[196:199], v212, s[16:19], s31 offen offset:128 sc1
    s_waitcnt lgkmcnt(2)
    buffer_store_dwordx4 a[200:203], v212, s[16:19], s31 offen offset:2176 sc1
    s_waitcnt lgkmcnt(1)
    buffer_store_dwordx4 a[204:207], v212, s[16:19], s44 offen offset:128 sc1
    s_waitcnt lgkmcnt(0)
    buffer_store_dwordx4 a[208:211], v212, s[16:19], s44 offen offset:2176 sc1
L_end:
    s_endpgm
L_rb0:
    s_nop 4
    v_mov_b32 v233, v229
    v_mov_b32 v234, v230
    v_mov_b32 v235, v231
    v_mov_b32 v236, v232
    v_permlane32_swap_b32 v229, v233
    v_permlane32_swap_b32 v230, v234
    v_permlane32_swap_b32 v231, v235
    v_permlane32_swap_b32 v232, v236
    v_max_f32 v229, v229, v233
    v_max_f32 v230, v230, v234
    v_max_f32 v231, v231, v235
    v_max_f32 v232, v232, v236
    v_mov_b32 v233, v229
    v_mov_b32 v234, v230
    v_mov_b32 v235, v231
    v_mov_b32 v236, v232
    v_permlane16_swap_b32 v229, v233
    v_permlane16_swap_b32 v230, v234
    v_permlane16_swap_b32 v231, v235
    v_permlane16_swap_b32 v232, v236
    v_max_f32 v229, v229, v233
    v_max_f32 v230, v230, v234
    v_max_f32 v231, v231, v235
    v_max_f32 v232, v232, v236
    v_subrev_f32 v233, 0x427af233, v217
    v_max_f32 v229, v229, v233
    v_mul_f32 v233, s28, v229
    v_sub_f32 v221, v213, v233
    v_exp_f32 v221, v221
    v_mov_b32 v213, v233
    v_add_f32 v217, 0x427af233, v229
    v_subrev_f32 v234, 0x427af233, v218
    v_max_f32 v230, v230, v234
    v_mul_f32 v234, s28, v230
    v_sub_f32 v223, v214, v234
    v_exp_f32 v223, v223
    v_mov_b32 v214, v234
    v_add_f32 v218, 0x427af233, v230
    v_subrev_f32 v235, 0x427af233, v219
    v_max_f32 v231, v231, v235
    v_mul_f32 v235, s28, v231
    v_sub_f32 v225, v215, v235
    v_exp_f32 v225, v225
    v_mov_b32 v215, v235
    v_add_f32 v219, 0x427af233, v231
    v_subrev_f32 v236, 0x427af233, v220
    v_max_f32 v232, v232, v236
    v_mul_f32 v236, s28, v232
    v_sub_f32 v227, v216, v236
    v_exp_f32 v227, v227
    v_mov_b32 v216, v236
    v_add_f32 v220, 0x427af233, v232
    s_mov_b32 s27, 1
    s_nop 4
    s_branch L_rbr0
L_rc0:
    s_nop 15
    v_mul_f32 v0, v0, v221
    v_mul_f32 v1, v1, v221
    v_mul_f32 v2, v2, v221
    v_mul_f32 v3, v3, v221
    v_mul_f32 v4, v4, v223
    v_mul_f32 v5, v5, v223
    v_mul_f32 v6, v6, v223
    v_mul_f32 v7, v7, v223
    v_mul_f32 v8, v8, v225
    v_mul_f32 v9, v9, v225
    v_mul_f32 v10, v10, v225
    v_mul_f32 v11, v11, v225
    v_mul_f32 v12, v12, v227
    v_mul_f32 v13, v13, v227
    v_mul_f32 v14, v14, v227
    v_mul_f32 v15, v15, v227
    v_mul_f32 v16, v16, v221
    v_mul_f32 v17, v17, v221
    v_mul_f32 v18, v18, v221
    v_mul_f32 v19, v19, v221
    v_mul_f32 v20, v20, v223
    v_mul_f32 v21, v21, v223
    v_mul_f32 v22, v22, v223
    v_mul_f32 v23, v23, v223
    v_mul_f32 v24, v24, v225
    v_mul_f32 v25, v25, v225
    v_mul_f32 v26, v26, v225
    v_mul_f32 v27, v27, v225
    v_mul_f32 v28, v28, v227
    v_mul_f32 v29, v29, v227
    v_mul_f32 v30, v30, v227
    v_mul_f32 v31, v31, v227
    v_mul_f32 v32, v32, v221
    v_mul_f32 v33, v33, v221
    v_mul_f32 v34, v34, v221
    v_mul_f32 v35, v35, v221
    v_mul_f32 v36, v36, v223
    v_mul_f32 v37, v37, v223
    v_mul_f32 v38, v38, v223
    v_mul_f32 v39, v39, v223
    v_mul_f32 v40, v40, v225
    v_mul_f32 v41, v41, v225
    v_mul_f32 v42, v42, v225
    v_mul_f32 v43, v43, v225
    v_mul_f32 v44, v44, v227
    v_mul_f32 v45, v45, v227
    v_mul_f32 v46, v46, v227
    v_mul_f32 v47, v47, v227
    v_mul_f32 v48, v48, v221
    v_mul_f32 v49, v49, v221
    v_mul_f32 v50, v50, v221
    v_mul_f32 v51, v51, v221
    v_mul_f32 v52, v52, v223
    v_mul_f32 v53, v53, v223
    v_mul_f32 v54, v54, v223
    v_mul_f32 v55, v55, v223
    v_mul_f32 v56, v56, v225
    v_mul_f32 v57, v57, v225
    v_mul_f32 v58, v58, v225
    v_mul_f32 v59, v59, v225
    v_mul_f32 v60, v60, v227
    v_mul_f32 v61, v61, v227
    v_mul_f32 v62, v62, v227
    v_mul_f32 v63, v63, v227
    v_mul_f32 v64, v64, v221
    v_mul_f32 v65, v65, v221
    v_mul_f32 v66, v66, v221
    v_mul_f32 v67, v67, v221
    v_mul_f32 v68, v68, v223
    v_mul_f32 v69, v69, v223
    v_mul_f32 v70, v70, v223
    v_mul_f32 v71, v71, v223
    v_mul_f32 v72, v72, v225
    v_mul_f32 v73, v73, v225
    v_mul_f32 v74, v74, v225
    v_mul_f32 v75, v75, v225
    v_mul_f32 v76, v76, v227
    v_mul_f32 v77, v77, v227
    v_mul_f32 v78, v78, v227
    v_mul_f32 v79, v79, v227
    v_mul_f32 v80, v80, v221
    v_mul_f32 v81, v81, v221
    v_mul_f32 v82, v82, v221
    v_mul_f32 v83, v83, v221
    v_mul_f32 v84, v84, v223
    v_mul_f32 v85, v85, v223
    v_mul_f32 v86, v86, v223
    v_mul_f32 v87, v87, v223
    v_mul_f32 v88, v88, v225
    v_mul_f32 v89, v89, v225
    v_mul_f32 v90, v90, v225
    v_mul_f32 v91, v91, v225
    v_mul_f32 v92, v92, v227
    v_mul_f32 v93, v93, v227
    v_mul_f32 v94, v94, v227
    v_mul_f32 v95, v95, v227
    v_mul_f32 v96, v96, v221
    v_mul_f32 v97, v97, v221
    v_mul_f32 v98, v98, v221
    v_mul_f32 v99, v99, v221
    v_mul_f32 v100, v100, v223
    v_mul_f32 v101, v101, v223
    v_mul_f32 v102, v102, v223
    v_mul_f32 v103, v103, v223
    v_mul_f32 v104, v104, v225
    v_mul_f32 v105, v105, v225
    v_mul_f32 v106, v106, v225
    v_mul_f32 v107, v107, v225
    v_mul_f32 v108, v108, v227
    v_mul_f32 v109, v109, v227
    v_mul_f32 v110, v110, v227
    v_mul_f32 v111, v111, v227
    v_mul_f32 v112, v112, v221
    v_mul_f32 v113, v113, v221
    v_mul_f32 v114, v114, v221
    v_mul_f32 v115, v115, v221
    v_mul_f32 v116, v116, v223
    v_mul_f32 v117, v117, v223
    v_mul_f32 v118, v118, v223
    v_mul_f32 v119, v119, v223
    v_mul_f32 v120, v120, v225
    v_mul_f32 v121, v121, v225
    v_mul_f32 v122, v122, v225
    v_mul_f32 v123, v123, v225
    v_mul_f32 v124, v124, v227
    v_mul_f32 v125, v125, v227
    v_mul_f32 v126, v126, v227
    v_mul_f32 v127, v127, v227
    v_accvgpr_read_b32 v233, a132
    v_mul_f32 v233, v233, v221
    s_nop 0
    v_accvgpr_write_b32 a132, v233
    v_accvgpr_read_b32 v233, a133
    v_mul_f32 v233, v233, v221
    s_nop 0
    v_accvgpr_write_b32 a133, v233
    v_accvgpr_read_b32 v233, a134
    v_mul_f32 v233, v233, v221
    s_nop 0
    v_accvgpr_write_b32 a134, v233
    v_accvgpr_read_b32 v233, a135
    v_mul_f32 v233, v233, v221
    s_nop 0
    v_accvgpr_write_b32 a135, v233
    v_accvgpr_read_b32 v233, a136
    v_mul_f32 v233, v233, v223
    s_nop 0
    v_accvgpr_write_b32 a136, v233
    v_accvgpr_read_b32 v233, a137
    v_mul_f32 v233, v233, v223
    s_nop 0
    v_accvgpr_write_b32 a137, v233
    v_accvgpr_read_b32 v233, a138
    v_mul_f32 v233, v233, v223
    s_nop 0
    v_accvgpr_write_b32 a138, v233
    v_accvgpr_read_b32 v233, a139
    v_mul_f32 v233, v233, v223
    s_nop 0
    v_accvgpr_write_b32 a139, v233
    v_accvgpr_read_b32 v233, a140
    v_mul_f32 v233, v233, v225
    s_nop 0
    v_accvgpr_write_b32 a140, v233
    v_accvgpr_read_b32 v233, a141
    v_mul_f32 v233, v233, v225
    s_nop 0
    v_accvgpr_write_b32 a141, v233
    v_accvgpr_read_b32 v233, a142
    v_mul_f32 v233, v233, v225
    s_nop 0
    v_accvgpr_write_b32 a142, v233
    v_accvgpr_read_b32 v233, a143
    v_mul_f32 v233, v233, v225
    s_nop 0
    v_accvgpr_write_b32 a143, v233
    v_accvgpr_read_b32 v233, a144
    v_mul_f32 v233, v233, v227
    s_nop 0
    v_accvgpr_write_b32 a144, v233
    v_accvgpr_read_b32 v233, a145
    v_mul_f32 v233, v233, v227
    s_nop 0
    v_accvgpr_write_b32 a145, v233
    v_accvgpr_read_b32 v233, a146
    v_mul_f32 v233, v233, v227
    s_nop 0
    v_accvgpr_write_b32 a146, v233
    v_accvgpr_read_b32 v233, a147
    v_mul_f32 v233, v233, v227
    s_nop 0
    v_accvgpr_write_b32 a147, v233
    s_mov_b32 s27, 0
    s_nop 4
    s_branch L_rcr0
L_rb1:
    s_nop 4
    v_mov_b32 v233, v229
    v_mov_b32 v234, v230
    v_mov_b32 v235, v231
    v_mov_b32 v236, v232
    v_permlane32_swap_b32 v229, v233
    v_permlane32_swap_b32 v230, v234
    v_permlane32_swap_b32 v231, v235
    v_permlane32_swap_b32 v232, v236
    v_max_f32 v229, v229, v233
    v_max_f32 v230, v230, v234
    v_max_f32 v231, v231, v235
    v_max_f32 v232, v232, v236
    v_mov_b32 v233, v229
    v_mov_b32 v234, v230
    v_mov_b32 v235, v231
    v_mov_b32 v236, v232
    v_permlane16_swap_b32 v229, v233
    v_permlane16_swap_b32 v230, v234
    v_permlane16_swap_b32 v231, v235
    v_permlane16_swap_b32 v232, v236
    v_max_f32 v229, v229, v233
    v_max_f32 v230, v230, v234
    v_max_f32 v231, v231, v235
    v_max_f32 v232, v232, v236
    v_subrev_f32 v233, 0x427af233, v217
    v_max_f32 v229, v229, v233
    v_mul_f32 v233, s28, v229
    v_sub_f32 v221, v213, v233
    v_exp_f32 v221, v221
    v_mov_b32 v213, v233
    v_add_f32 v217, 0x427af233, v229
    v_subrev_f32 v234, 0x427af233, v218
    v_max_f32 v230, v230, v234
    v_mul_f32 v234, s28, v230
    v_sub_f32 v223, v214, v234
    v_exp_f32 v223, v223
    v_mov_b32 v214, v234
    v_add_f32 v218, 0x427af233, v230
    v_subrev_f32 v235, 0x427af233, v219
    v_max_f32 v231, v231, v235
    v_mul_f32 v235, s28, v231
    v_sub_f32 v225, v215, v235
    v_exp_f32 v225, v225
    v_mov_b32 v215, v235
    v_add_f32 v219, 0x427af233, v231
    v_subrev_f32 v236, 0x427af233, v220
    v_max_f32 v232, v232, v236
    v_mul_f32 v236, s28, v232
    v_sub_f32 v227, v216, v236
    v_exp_f32 v227, v227
    v_mov_b32 v216, v236
    v_add_f32 v220, 0x427af233, v232
    s_mov_b32 s27, 1
    s_nop 4
    s_branch L_rbr1
L_rc1:
    s_nop 15
    v_mul_f32 v0, v0, v221
    v_mul_f32 v1, v1, v221
    v_mul_f32 v2, v2, v221
    v_mul_f32 v3, v3, v221
    v_mul_f32 v4, v4, v223
    v_mul_f32 v5, v5, v223
    v_mul_f32 v6, v6, v223
    v_mul_f32 v7, v7, v223
    v_mul_f32 v8, v8, v225
    v_mul_f32 v9, v9, v225
    v_mul_f32 v10, v10, v225
    v_mul_f32 v11, v11, v225
    v_mul_f32 v12, v12, v227
    v_mul_f32 v13, v13, v227
    v_mul_f32 v14, v14, v227
    v_mul_f32 v15, v15, v227
    v_mul_f32 v16, v16, v221
    v_mul_f32 v17, v17, v221
    v_mul_f32 v18, v18, v221
    v_mul_f32 v19, v19, v221
    v_mul_f32 v20, v20, v223
    v_mul_f32 v21, v21, v223
    v_mul_f32 v22, v22, v223
    v_mul_f32 v23, v23, v223
    v_mul_f32 v24, v24, v225
    v_mul_f32 v25, v25, v225
    v_mul_f32 v26, v26, v225
    v_mul_f32 v27, v27, v225
    v_mul_f32 v28, v28, v227
    v_mul_f32 v29, v29, v227
    v_mul_f32 v30, v30, v227
    v_mul_f32 v31, v31, v227
    v_mul_f32 v32, v32, v221
    v_mul_f32 v33, v33, v221
    v_mul_f32 v34, v34, v221
    v_mul_f32 v35, v35, v221
    v_mul_f32 v36, v36, v223
    v_mul_f32 v37, v37, v223
    v_mul_f32 v38, v38, v223
    v_mul_f32 v39, v39, v223
    v_mul_f32 v40, v40, v225
    v_mul_f32 v41, v41, v225
    v_mul_f32 v42, v42, v225
    v_mul_f32 v43, v43, v225
    v_mul_f32 v44, v44, v227
    v_mul_f32 v45, v45, v227
    v_mul_f32 v46, v46, v227
    v_mul_f32 v47, v47, v227
    v_mul_f32 v48, v48, v221
    v_mul_f32 v49, v49, v221
    v_mul_f32 v50, v50, v221
    v_mul_f32 v51, v51, v221
    v_mul_f32 v52, v52, v223
    v_mul_f32 v53, v53, v223
    v_mul_f32 v54, v54, v223
    v_mul_f32 v55, v55, v223
    v_mul_f32 v56, v56, v225
    v_mul_f32 v57, v57, v225
    v_mul_f32 v58, v58, v225
    v_mul_f32 v59, v59, v225
    v_mul_f32 v60, v60, v227
    v_mul_f32 v61, v61, v227
    v_mul_f32 v62, v62, v227
    v_mul_f32 v63, v63, v227
    v_mul_f32 v64, v64, v221
    v_mul_f32 v65, v65, v221
    v_mul_f32 v66, v66, v221
    v_mul_f32 v67, v67, v221
    v_mul_f32 v68, v68, v223
    v_mul_f32 v69, v69, v223
    v_mul_f32 v70, v70, v223
    v_mul_f32 v71, v71, v223
    v_mul_f32 v72, v72, v225
    v_mul_f32 v73, v73, v225
    v_mul_f32 v74, v74, v225
    v_mul_f32 v75, v75, v225
    v_mul_f32 v76, v76, v227
    v_mul_f32 v77, v77, v227
    v_mul_f32 v78, v78, v227
    v_mul_f32 v79, v79, v227
    v_mul_f32 v80, v80, v221
    v_mul_f32 v81, v81, v221
    v_mul_f32 v82, v82, v221
    v_mul_f32 v83, v83, v221
    v_mul_f32 v84, v84, v223
    v_mul_f32 v85, v85, v223
    v_mul_f32 v86, v86, v223
    v_mul_f32 v87, v87, v223
    v_mul_f32 v88, v88, v225
    v_mul_f32 v89, v89, v225
    v_mul_f32 v90, v90, v225
    v_mul_f32 v91, v91, v225
    v_mul_f32 v92, v92, v227
    v_mul_f32 v93, v93, v227
    v_mul_f32 v94, v94, v227
    v_mul_f32 v95, v95, v227
    v_mul_f32 v96, v96, v221
    v_mul_f32 v97, v97, v221
    v_mul_f32 v98, v98, v221
    v_mul_f32 v99, v99, v221
    v_mul_f32 v100, v100, v223
    v_mul_f32 v101, v101, v223
    v_mul_f32 v102, v102, v223
    v_mul_f32 v103, v103, v223
    v_mul_f32 v104, v104, v225
    v_mul_f32 v105, v105, v225
    v_mul_f32 v106, v106, v225
    v_mul_f32 v107, v107, v225
    v_mul_f32 v108, v108, v227
    v_mul_f32 v109, v109, v227
    v_mul_f32 v110, v110, v227
    v_mul_f32 v111, v111, v227
    v_mul_f32 v112, v112, v221
    v_mul_f32 v113, v113, v221
    v_mul_f32 v114, v114, v221
    v_mul_f32 v115, v115, v221
    v_mul_f32 v116, v116, v223
    v_mul_f32 v117, v117, v223
    v_mul_f32 v118, v118, v223
    v_mul_f32 v119, v119, v223
    v_mul_f32 v120, v120, v225
    v_mul_f32 v121, v121, v225
    v_mul_f32 v122, v122, v225
    v_mul_f32 v123, v123, v225
    v_mul_f32 v124, v124, v227
    v_mul_f32 v125, v125, v227
    v_mul_f32 v126, v126, v227
    v_mul_f32 v127, v127, v227
    v_accvgpr_read_b32 v233, a132
    v_mul_f32 v233, v233, v221
    s_nop 0
    v_accvgpr_write_b32 a132, v233
    v_accvgpr_read_b32 v233, a133
    v_mul_f32 v233, v233, v221
    s_nop 0
    v_accvgpr_write_b32 a133, v233
    v_accvgpr_read_b32 v233, a134
    v_mul_f32 v233, v233, v221
    s_nop 0
    v_accvgpr_write_b32 a134, v233
    v_accvgpr_read_b32 v233, a135
    v_mul_f32 v233, v233, v221
    s_nop 0
    v_accvgpr_write_b32 a135, v233
    v_accvgpr_read_b32 v233, a136
    v_mul_f32 v233, v233, v223
    s_nop 0
    v_accvgpr_write_b32 a136, v233
    v_accvgpr_read_b32 v233, a137
    v_mul_f32 v233, v233, v223
    s_nop 0
    v_accvgpr_write_b32 a137, v233
    v_accvgpr_read_b32 v233, a138
    v_mul_f32 v233, v233, v223
    s_nop 0
    v_accvgpr_write_b32 a138, v233
    v_accvgpr_read_b32 v233, a139
    v_mul_f32 v233, v233, v223
    s_nop 0
    v_accvgpr_write_b32 a139, v233
    v_accvgpr_read_b32 v233, a140
    v_mul_f32 v233, v233, v225
    s_nop 0
    v_accvgpr_write_b32 a140, v233
    v_accvgpr_read_b32 v233, a141
    v_mul_f32 v233, v233, v225
    s_nop 0
    v_accvgpr_write_b32 a141, v233
    v_accvgpr_read_b32 v233, a142
    v_mul_f32 v233, v233, v225
    s_nop 0
    v_accvgpr_write_b32 a142, v233
    v_accvgpr_read_b32 v233, a143
    v_mul_f32 v233, v233, v225
    s_nop 0
    v_accvgpr_write_b32 a143, v233
    v_accvgpr_read_b32 v233, a144
    v_mul_f32 v233, v233, v227
    s_nop 0
    v_accvgpr_write_b32 a144, v233
    v_accvgpr_read_b32 v233, a145
    v_mul_f32 v233, v233, v227
    s_nop 0
    v_accvgpr_write_b32 a145, v233
    v_accvgpr_read_b32 v233, a146
    v_mul_f32 v233, v233, v227
    s_nop 0
    v_accvgpr_write_b32 a146, v233
    v_accvgpr_read_b32 v233, a147
    v_mul_f32 v233, v233, v227
    s_nop 0
    v_accvgpr_write_b32 a147, v233
    s_mov_b32 s27, 0
    s_nop 4
    s_branch L_rcr1
L_rb2:
    s_nop 4
    v_mov_b32 v233, v229
    v_mov_b32 v234, v230
    v_mov_b32 v235, v231
    v_mov_b32 v236, v232
    v_permlane32_swap_b32 v229, v233
    v_permlane32_swap_b32 v230, v234
    v_permlane32_swap_b32 v231, v235
    v_permlane32_swap_b32 v232, v236
    v_max_f32 v229, v229, v233
    v_max_f32 v230, v230, v234
    v_max_f32 v231, v231, v235
    v_max_f32 v232, v232, v236
    v_mov_b32 v233, v229
    v_mov_b32 v234, v230
    v_mov_b32 v235, v231
    v_mov_b32 v236, v232
    v_permlane16_swap_b32 v229, v233
    v_permlane16_swap_b32 v230, v234
    v_permlane16_swap_b32 v231, v235
    v_permlane16_swap_b32 v232, v236
    v_max_f32 v229, v229, v233
    v_max_f32 v230, v230, v234
    v_max_f32 v231, v231, v235
    v_max_f32 v232, v232, v236
    v_subrev_f32 v233, 0x427af233, v217
    v_max_f32 v229, v229, v233
    v_mul_f32 v233, s28, v229
    v_sub_f32 v221, v213, v233
    v_exp_f32 v221, v221
    v_mov_b32 v213, v233
    v_add_f32 v217, 0x427af233, v229
    v_subrev_f32 v234, 0x427af233, v218
    v_max_f32 v230, v230, v234
    v_mul_f32 v234, s28, v230
    v_sub_f32 v223, v214, v234
    v_exp_f32 v223, v223
    v_mov_b32 v214, v234
    v_add_f32 v218, 0x427af233, v230
    v_subrev_f32 v235, 0x427af233, v219
    v_max_f32 v231, v231, v235
    v_mul_f32 v235, s28, v231
    v_sub_f32 v225, v215, v235
    v_exp_f32 v225, v225
    v_mov_b32 v215, v235
    v_add_f32 v219, 0x427af233, v231
    v_subrev_f32 v236, 0x427af233, v220
    v_max_f32 v232, v232, v236
    v_mul_f32 v236, s28, v232
    v_sub_f32 v227, v216, v236
    v_exp_f32 v227, v227
    v_mov_b32 v216, v236
    v_add_f32 v220, 0x427af233, v232
    s_mov_b32 s27, 1
    s_nop 4
    s_branch L_rbr2
L_rc2:
    s_nop 15
    v_mul_f32 v0, v0, v221
    v_mul_f32 v1, v1, v221
    v_mul_f32 v2, v2, v221
    v_mul_f32 v3, v3, v221
    v_mul_f32 v4, v4, v223
    v_mul_f32 v5, v5, v223
    v_mul_f32 v6, v6, v223
    v_mul_f32 v7, v7, v223
    v_mul_f32 v8, v8, v225
    v_mul_f32 v9, v9, v225
    v_mul_f32 v10, v10, v225
    v_mul_f32 v11, v11, v225
    v_mul_f32 v12, v12, v227
    v_mul_f32 v13, v13, v227
    v_mul_f32 v14, v14, v227
    v_mul_f32 v15, v15, v227
    v_mul_f32 v16, v16, v221
    v_mul_f32 v17, v17, v221
    v_mul_f32 v18, v18, v221
    v_mul_f32 v19, v19, v221
    v_mul_f32 v20, v20, v223
    v_mul_f32 v21, v21, v223
    v_mul_f32 v22, v22, v223
    v_mul_f32 v23, v23, v223
    v_mul_f32 v24, v24, v225
    v_mul_f32 v25, v25, v225
    v_mul_f32 v26, v26, v225
    v_mul_f32 v27, v27, v225
    v_mul_f32 v28, v28, v227
    v_mul_f32 v29, v29, v227
    v_mul_f32 v30, v30, v227
    v_mul_f32 v31, v31, v227
    v_mul_f32 v32, v32, v221
    v_mul_f32 v33, v33, v221
    v_mul_f32 v34, v34, v221
    v_mul_f32 v35, v35, v221
    v_mul_f32 v36, v36, v223
    v_mul_f32 v37, v37, v223
    v_mul_f32 v38, v38, v223
    v_mul_f32 v39, v39, v223
    v_mul_f32 v40, v40, v225
    v_mul_f32 v41, v41, v225
    v_mul_f32 v42, v42, v225
    v_mul_f32 v43, v43, v225
    v_mul_f32 v44, v44, v227
    v_mul_f32 v45, v45, v227
    v_mul_f32 v46, v46, v227
    v_mul_f32 v47, v47, v227
    v_mul_f32 v48, v48, v221
    v_mul_f32 v49, v49, v221
    v_mul_f32 v50, v50, v221
    v_mul_f32 v51, v51, v221
    v_mul_f32 v52, v52, v223
    v_mul_f32 v53, v53, v223
    v_mul_f32 v54, v54, v223
    v_mul_f32 v55, v55, v223
    v_mul_f32 v56, v56, v225
    v_mul_f32 v57, v57, v225
    v_mul_f32 v58, v58, v225
    v_mul_f32 v59, v59, v225
    v_mul_f32 v60, v60, v227
    v_mul_f32 v61, v61, v227
    v_mul_f32 v62, v62, v227
    v_mul_f32 v63, v63, v227
    v_mul_f32 v64, v64, v221
    v_mul_f32 v65, v65, v221
    v_mul_f32 v66, v66, v221
    v_mul_f32 v67, v67, v221
    v_mul_f32 v68, v68, v223
    v_mul_f32 v69, v69, v223
    v_mul_f32 v70, v70, v223
    v_mul_f32 v71, v71, v223
    v_mul_f32 v72, v72, v225
    v_mul_f32 v73, v73, v225
    v_mul_f32 v74, v74, v225
    v_mul_f32 v75, v75, v225
    v_mul_f32 v76, v76, v227
    v_mul_f32 v77, v77, v227
    v_mul_f32 v78, v78, v227
    v_mul_f32 v79, v79, v227
    v_mul_f32 v80, v80, v221
    v_mul_f32 v81, v81, v221
    v_mul_f32 v82, v82, v221
    v_mul_f32 v83, v83, v221
    v_mul_f32 v84, v84, v223
    v_mul_f32 v85, v85, v223
    v_mul_f32 v86, v86, v223
    v_mul_f32 v87, v87, v223
    v_mul_f32 v88, v88, v225
    v_mul_f32 v89, v89, v225
    v_mul_f32 v90, v90, v225
    v_mul_f32 v91, v91, v225
    v_mul_f32 v92, v92, v227
    v_mul_f32 v93, v93, v227
    v_mul_f32 v94, v94, v227
    v_mul_f32 v95, v95, v227
    v_mul_f32 v96, v96, v221
    v_mul_f32 v97, v97, v221
    v_mul_f32 v98, v98, v221
    v_mul_f32 v99, v99, v221
    v_mul_f32 v100, v100, v223
    v_mul_f32 v101, v101, v223
    v_mul_f32 v102, v102, v223
    v_mul_f32 v103, v103, v223
    v_mul_f32 v104, v104, v225
    v_mul_f32 v105, v105, v225
    v_mul_f32 v106, v106, v225
    v_mul_f32 v107, v107, v225
    v_mul_f32 v108, v108, v227
    v_mul_f32 v109, v109, v227
    v_mul_f32 v110, v110, v227
    v_mul_f32 v111, v111, v227
    v_mul_f32 v112, v112, v221
    v_mul_f32 v113, v113, v221
    v_mul_f32 v114, v114, v221
    v_mul_f32 v115, v115, v221
    v_mul_f32 v116, v116, v223
    v_mul_f32 v117, v117, v223
    v_mul_f32 v118, v118, v223
    v_mul_f32 v119, v119, v223
    v_mul_f32 v120, v120, v225
    v_mul_f32 v121, v121, v225
    v_mul_f32 v122, v122, v225
    v_mul_f32 v123, v123, v225
    v_mul_f32 v124, v124, v227
    v_mul_f32 v125, v125, v227
    v_mul_f32 v126, v126, v227
    v_mul_f32 v127, v127, v227
    v_accvgpr_read_b32 v233, a132
    v_mul_f32 v233, v233, v221
    s_nop 0
    v_accvgpr_write_b32 a132, v233
    v_accvgpr_read_b32 v233, a133
    v_mul_f32 v233, v233, v221
    s_nop 0
    v_accvgpr_write_b32 a133, v233
    v_accvgpr_read_b32 v233, a134
    v_mul_f32 v233, v233, v221
    s_nop 0
    v_accvgpr_write_b32 a134, v233
    v_accvgpr_read_b32 v233, a135
    v_mul_f32 v233, v233, v221
    s_nop 0
    v_accvgpr_write_b32 a135, v233
    v_accvgpr_read_b32 v233, a136
    v_mul_f32 v233, v233, v223
    s_nop 0
    v_accvgpr_write_b32 a136, v233
    v_accvgpr_read_b32 v233, a137
    v_mul_f32 v233, v233, v223
    s_nop 0
    v_accvgpr_write_b32 a137, v233
    v_accvgpr_read_b32 v233, a138
    v_mul_f32 v233, v233, v223
    s_nop 0
    v_accvgpr_write_b32 a138, v233
    v_accvgpr_read_b32 v233, a139
    v_mul_f32 v233, v233, v223
    s_nop 0
    v_accvgpr_write_b32 a139, v233
    v_accvgpr_read_b32 v233, a140
    v_mul_f32 v233, v233, v225
    s_nop 0
    v_accvgpr_write_b32 a140, v233
    v_accvgpr_read_b32 v233, a141
    v_mul_f32 v233, v233, v225
    s_nop 0
    v_accvgpr_write_b32 a141, v233
    v_accvgpr_read_b32 v233, a142
    v_mul_f32 v233, v233, v225
    s_nop 0
    v_accvgpr_write_b32 a142, v233
    v_accvgpr_read_b32 v233, a143
    v_mul_f32 v233, v233, v225
    s_nop 0
    v_accvgpr_write_b32 a143, v233
    v_accvgpr_read_b32 v233, a144
    v_mul_f32 v233, v233, v227
    s_nop 0
    v_accvgpr_write_b32 a144, v233
    v_accvgpr_read_b32 v233, a145
    v_mul_f32 v233, v233, v227
    s_nop 0
    v_accvgpr_write_b32 a145, v233
    v_accvgpr_read_b32 v233, a146
    v_mul_f32 v233, v233, v227
    s_nop 0
    v_accvgpr_write_b32 a146, v233
    v_accvgpr_read_b32 v233, a147
    v_mul_f32 v233, v233, v227
    s_nop 0
    v_accvgpr_write_b32 a147, v233
    s_mov_b32 s27, 0
    s_nop 4
    s_branch L_rcr2
L_rb3:
    s_nop 4
    v_mov_b32 v233, v229
    v_mov_b32 v234, v230
    v_mov_b32 v235, v231
    v_mov_b32 v236, v232
    v_permlane32_swap_b32 v229, v233
    v_permlane32_swap_b32 v230, v234
    v_permlane32_swap_b32 v231, v235
    v_permlane32_swap_b32 v232, v236
    v_max_f32 v229, v229, v233
    v_max_f32 v230, v230, v234
    v_max_f32 v231, v231, v235
    v_max_f32 v232, v232, v236
    v_mov_b32 v233, v229
    v_mov_b32 v234, v230
    v_mov_b32 v235, v231
    v_mov_b32 v236, v232
    v_permlane16_swap_b32 v229, v233
    v_permlane16_swap_b32 v230, v234
    v_permlane16_swap_b32 v231, v235
    v_permlane16_swap_b32 v232, v236
    v_max_f32 v229, v229, v233
    v_max_f32 v230, v230, v234
    v_max_f32 v231, v231, v235
    v_max_f32 v232, v232, v236
    v_subrev_f32 v233, 0x427af233, v217
    v_max_f32 v229, v229, v233
    v_mul_f32 v233, s28, v229
    v_sub_f32 v221, v213, v233
    v_exp_f32 v221, v221
    v_mov_b32 v213, v233
    v_add_f32 v217, 0x427af233, v229
    v_subrev_f32 v234, 0x427af233, v218
    v_max_f32 v230, v230, v234
    v_mul_f32 v234, s28, v230
    v_sub_f32 v223, v214, v234
    v_exp_f32 v223, v223
    v_mov_b32 v214, v234
    v_add_f32 v218, 0x427af233, v230
    v_subrev_f32 v235, 0x427af233, v219
    v_max_f32 v231, v231, v235
    v_mul_f32 v235, s28, v231
    v_sub_f32 v225, v215, v235
    v_exp_f32 v225, v225
    v_mov_b32 v215, v235
    v_add_f32 v219, 0x427af233, v231
    v_subrev_f32 v236, 0x427af233, v220
    v_max_f32 v232, v232, v236
    v_mul_f32 v236, s28, v232
    v_sub_f32 v227, v216, v236
    v_exp_f32 v227, v227
    v_mov_b32 v216, v236
    v_add_f32 v220, 0x427af233, v232
    s_mov_b32 s27, 1
    s_nop 4
    s_branch L_rbr3
L_rc3:
    s_nop 15
    v_mul_f32 v0, v0, v221
    v_mul_f32 v1, v1, v221
    v_mul_f32 v2, v2, v221
    v_mul_f32 v3, v3, v221
    v_mul_f32 v4, v4, v223
    v_mul_f32 v5, v5, v223
    v_mul_f32 v6, v6, v223
    v_mul_f32 v7, v7, v223
    v_mul_f32 v8, v8, v225
    v_mul_f32 v9, v9, v225
    v_mul_f32 v10, v10, v225
    v_mul_f32 v11, v11, v225
    v_mul_f32 v12, v12, v227
    v_mul_f32 v13, v13, v227
    v_mul_f32 v14, v14, v227
    v_mul_f32 v15, v15, v227
    v_mul_f32 v16, v16, v221
    v_mul_f32 v17, v17, v221
    v_mul_f32 v18, v18, v221
    v_mul_f32 v19, v19, v221
    v_mul_f32 v20, v20, v223
    v_mul_f32 v21, v21, v223
    v_mul_f32 v22, v22, v223
    v_mul_f32 v23, v23, v223
    v_mul_f32 v24, v24, v225
    v_mul_f32 v25, v25, v225
    v_mul_f32 v26, v26, v225
    v_mul_f32 v27, v27, v225
    v_mul_f32 v28, v28, v227
    v_mul_f32 v29, v29, v227
    v_mul_f32 v30, v30, v227
    v_mul_f32 v31, v31, v227
    v_mul_f32 v32, v32, v221
    v_mul_f32 v33, v33, v221
    v_mul_f32 v34, v34, v221
    v_mul_f32 v35, v35, v221
    v_mul_f32 v36, v36, v223
    v_mul_f32 v37, v37, v223
    v_mul_f32 v38, v38, v223
    v_mul_f32 v39, v39, v223
    v_mul_f32 v40, v40, v225
    v_mul_f32 v41, v41, v225
    v_mul_f32 v42, v42, v225
    v_mul_f32 v43, v43, v225
    v_mul_f32 v44, v44, v227
    v_mul_f32 v45, v45, v227
    v_mul_f32 v46, v46, v227
    v_mul_f32 v47, v47, v227
    v_mul_f32 v48, v48, v221
    v_mul_f32 v49, v49, v221
    v_mul_f32 v50, v50, v221
    v_mul_f32 v51, v51, v221
    v_mul_f32 v52, v52, v223
    v_mul_f32 v53, v53, v223
    v_mul_f32 v54, v54, v223
    v_mul_f32 v55, v55, v223
    v_mul_f32 v56, v56, v225
    v_mul_f32 v57, v57, v225
    v_mul_f32 v58, v58, v225
    v_mul_f32 v59, v59, v225
    v_mul_f32 v60, v60, v227
    v_mul_f32 v61, v61, v227
    v_mul_f32 v62, v62, v227
    v_mul_f32 v63, v63, v227
    v_mul_f32 v64, v64, v221
    v_mul_f32 v65, v65, v221
    v_mul_f32 v66, v66, v221
    v_mul_f32 v67, v67, v221
    v_mul_f32 v68, v68, v223
    v_mul_f32 v69, v69, v223
    v_mul_f32 v70, v70, v223
    v_mul_f32 v71, v71, v223
    v_mul_f32 v72, v72, v225
    v_mul_f32 v73, v73, v225
    v_mul_f32 v74, v74, v225
    v_mul_f32 v75, v75, v225
    v_mul_f32 v76, v76, v227
    v_mul_f32 v77, v77, v227
    v_mul_f32 v78, v78, v227
    v_mul_f32 v79, v79, v227
    v_mul_f32 v80, v80, v221
    v_mul_f32 v81, v81, v221
    v_mul_f32 v82, v82, v221
    v_mul_f32 v83, v83, v221
    v_mul_f32 v84, v84, v223
    v_mul_f32 v85, v85, v223
    v_mul_f32 v86, v86, v223
    v_mul_f32 v87, v87, v223
    v_mul_f32 v88, v88, v225
    v_mul_f32 v89, v89, v225
    v_mul_f32 v90, v90, v225
    v_mul_f32 v91, v91, v225
    v_mul_f32 v92, v92, v227
    v_mul_f32 v93, v93, v227
    v_mul_f32 v94, v94, v227
    v_mul_f32 v95, v95, v227
    v_mul_f32 v96, v96, v221
    v_mul_f32 v97, v97, v221
    v_mul_f32 v98, v98, v221
    v_mul_f32 v99, v99, v221
    v_mul_f32 v100, v100, v223
    v_mul_f32 v101, v101, v223
    v_mul_f32 v102, v102, v223
    v_mul_f32 v103, v103, v223
    v_mul_f32 v104, v104, v225
    v_mul_f32 v105, v105, v225
    v_mul_f32 v106, v106, v225
    v_mul_f32 v107, v107, v225
    v_mul_f32 v108, v108, v227
    v_mul_f32 v109, v109, v227
    v_mul_f32 v110, v110, v227
    v_mul_f32 v111, v111, v227
    v_mul_f32 v112, v112, v221
    v_mul_f32 v113, v113, v221
    v_mul_f32 v114, v114, v221
    v_mul_f32 v115, v115, v221
    v_mul_f32 v116, v116, v223
    v_mul_f32 v117, v117, v223
    v_mul_f32 v118, v118, v223
    v_mul_f32 v119, v119, v223
    v_mul_f32 v120, v120, v225
    v_mul_f32 v121, v121, v225
    v_mul_f32 v122, v122, v225
    v_mul_f32 v123, v123, v225
    v_mul_f32 v124, v124, v227
    v_mul_f32 v125, v125, v227
    v_mul_f32 v126, v126, v227
    v_mul_f32 v127, v127, v227
    v_accvgpr_read_b32 v233, a132
    v_mul_f32 v233, v233, v221
    s_nop 0
    v_accvgpr_write_b32 a132, v233
    v_accvgpr_read_b32 v233, a133
    v_mul_f32 v233, v233, v221
    s_nop 0
    v_accvgpr_write_b32 a133, v233
    v_accvgpr_read_b32 v233, a134
    v_mul_f32 v233, v233, v221
    s_nop 0
    v_accvgpr_write_b32 a134, v233
    v_accvgpr_read_b32 v233, a135
    v_mul_f32 v233, v233, v221
    s_nop 0
    v_accvgpr_write_b32 a135, v233
    v_accvgpr_read_b32 v233, a136
    v_mul_f32 v233, v233, v223
    s_nop 0
    v_accvgpr_write_b32 a136, v233
    v_accvgpr_read_b32 v233, a137
    v_mul_f32 v233, v233, v223
    s_nop 0
    v_accvgpr_write_b32 a137, v233
    v_accvgpr_read_b32 v233, a138
    v_mul_f32 v233, v233, v223
    s_nop 0
    v_accvgpr_write_b32 a138, v233
    v_accvgpr_read_b32 v233, a139
    v_mul_f32 v233, v233, v223
    s_nop 0
    v_accvgpr_write_b32 a139, v233
    v_accvgpr_read_b32 v233, a140
    v_mul_f32 v233, v233, v225
    s_nop 0
    v_accvgpr_write_b32 a140, v233
    v_accvgpr_read_b32 v233, a141
    v_mul_f32 v233, v233, v225
    s_nop 0
    v_accvgpr_write_b32 a141, v233
    v_accvgpr_read_b32 v233, a142
    v_mul_f32 v233, v233, v225
    s_nop 0
    v_accvgpr_write_b32 a142, v233
    v_accvgpr_read_b32 v233, a143
    v_mul_f32 v233, v233, v225
    s_nop 0
    v_accvgpr_write_b32 a143, v233
    v_accvgpr_read_b32 v233, a144
    v_mul_f32 v233, v233, v227
    s_nop 0
    v_accvgpr_write_b32 a144, v233
    v_accvgpr_read_b32 v233, a145
    v_mul_f32 v233, v233, v227
    s_nop 0
    v_accvgpr_write_b32 a145, v233
    v_accvgpr_read_b32 v233, a146
    v_mul_f32 v233, v233, v227
    s_nop 0
    v_accvgpr_write_b32 a146, v233
    v_accvgpr_read_b32 v233, a147
    v_mul_f32 v233, v233, v227
    s_nop 0
    v_accvgpr_write_b32 a147, v233
    s_mov_b32 s27, 0
    s_nop 4
    s_branch L_rcr3
L_rb4:
    s_nop 4
    v_mov_b32 v233, v229
    v_mov_b32 v234, v230
    v_mov_b32 v235, v231
    v_mov_b32 v236, v232
    v_permlane32_swap_b32 v229, v233
    v_permlane32_swap_b32 v230, v234
    v_permlane32_swap_b32 v231, v235
    v_permlane32_swap_b32 v232, v236
    v_max_f32 v229, v229, v233
    v_max_f32 v230, v230, v234
    v_max_f32 v231, v231, v235
    v_max_f32 v232, v232, v236
    v_mov_b32 v233, v229
    v_mov_b32 v234, v230
    v_mov_b32 v235, v231
    v_mov_b32 v236, v232
    v_permlane16_swap_b32 v229, v233
    v_permlane16_swap_b32 v230, v234
    v_permlane16_swap_b32 v231, v235
    v_permlane16_swap_b32 v232, v236
    v_max_f32 v229, v229, v233
    v_max_f32 v230, v230, v234
    v_max_f32 v231, v231, v235
    v_max_f32 v232, v232, v236
    v_subrev_f32 v233, 0x427af233, v217
    v_max_f32 v229, v229, v233
    v_mul_f32 v233, s28, v229
    v_sub_f32 v221, v213, v233
    v_exp_f32 v221, v221
    v_mov_b32 v213, v233
    v_add_f32 v217, 0x427af233, v229
    v_subrev_f32 v234, 0x427af233, v218
    v_max_f32 v230, v230, v234
    v_mul_f32 v234, s28, v230
    v_sub_f32 v223, v214, v234
    v_exp_f32 v223, v223
    v_mov_b32 v214, v234
    v_add_f32 v218, 0x427af233, v230
    v_subrev_f32 v235, 0x427af233, v219
    v_max_f32 v231, v231, v235
    v_mul_f32 v235, s28, v231
    v_sub_f32 v225, v215, v235
    v_exp_f32 v225, v225
    v_mov_b32 v215, v235
    v_add_f32 v219, 0x427af233, v231
    v_subrev_f32 v236, 0x427af233, v220
    v_max_f32 v232, v232, v236
    v_mul_f32 v236, s28, v232
    v_sub_f32 v227, v216, v236
    v_exp_f32 v227, v227
    v_mov_b32 v216, v236
    v_add_f32 v220, 0x427af233, v232
    s_mov_b32 s27, 1
    s_nop 4
    s_branch L_rbr4
L_rc4:
    s_nop 15
    v_mul_f32 v0, v0, v221
    v_mul_f32 v1, v1, v221
    v_mul_f32 v2, v2, v221
    v_mul_f32 v3, v3, v221
    v_mul_f32 v4, v4, v223
    v_mul_f32 v5, v5, v223
    v_mul_f32 v6, v6, v223
    v_mul_f32 v7, v7, v223
    v_mul_f32 v8, v8, v225
    v_mul_f32 v9, v9, v225
    v_mul_f32 v10, v10, v225
    v_mul_f32 v11, v11, v225
    v_mul_f32 v12, v12, v227
    v_mul_f32 v13, v13, v227
    v_mul_f32 v14, v14, v227
    v_mul_f32 v15, v15, v227
    v_mul_f32 v16, v16, v221
    v_mul_f32 v17, v17, v221
    v_mul_f32 v18, v18, v221
    v_mul_f32 v19, v19, v221
    v_mul_f32 v20, v20, v223
    v_mul_f32 v21, v21, v223
    v_mul_f32 v22, v22, v223
    v_mul_f32 v23, v23, v223
    v_mul_f32 v24, v24, v225
    v_mul_f32 v25, v25, v225
    v_mul_f32 v26, v26, v225
    v_mul_f32 v27, v27, v225
    v_mul_f32 v28, v28, v227
    v_mul_f32 v29, v29, v227
    v_mul_f32 v30, v30, v227
    v_mul_f32 v31, v31, v227
    v_mul_f32 v32, v32, v221
    v_mul_f32 v33, v33, v221
    v_mul_f32 v34, v34, v221
    v_mul_f32 v35, v35, v221
    v_mul_f32 v36, v36, v223
    v_mul_f32 v37, v37, v223
    v_mul_f32 v38, v38, v223
    v_mul_f32 v39, v39, v223
    v_mul_f32 v40, v40, v225
    v_mul_f32 v41, v41, v225
    v_mul_f32 v42, v42, v225
    v_mul_f32 v43, v43, v225
    v_mul_f32 v44, v44, v227
    v_mul_f32 v45, v45, v227
    v_mul_f32 v46, v46, v227
    v_mul_f32 v47, v47, v227
    v_mul_f32 v48, v48, v221
    v_mul_f32 v49, v49, v221
    v_mul_f32 v50, v50, v221
    v_mul_f32 v51, v51, v221
    v_mul_f32 v52, v52, v223
    v_mul_f32 v53, v53, v223
    v_mul_f32 v54, v54, v223
    v_mul_f32 v55, v55, v223
    v_mul_f32 v56, v56, v225
    v_mul_f32 v57, v57, v225
    v_mul_f32 v58, v58, v225
    v_mul_f32 v59, v59, v225
    v_mul_f32 v60, v60, v227
    v_mul_f32 v61, v61, v227
    v_mul_f32 v62, v62, v227
    v_mul_f32 v63, v63, v227
    v_mul_f32 v64, v64, v221
    v_mul_f32 v65, v65, v221
    v_mul_f32 v66, v66, v221
    v_mul_f32 v67, v67, v221
    v_mul_f32 v68, v68, v223
    v_mul_f32 v69, v69, v223
    v_mul_f32 v70, v70, v223
    v_mul_f32 v71, v71, v223
    v_mul_f32 v72, v72, v225
    v_mul_f32 v73, v73, v225
    v_mul_f32 v74, v74, v225
    v_mul_f32 v75, v75, v225
    v_mul_f32 v76, v76, v227
    v_mul_f32 v77, v77, v227
    v_mul_f32 v78, v78, v227
    v_mul_f32 v79, v79, v227
    v_mul_f32 v80, v80, v221
    v_mul_f32 v81, v81, v221
    v_mul_f32 v82, v82, v221
    v_mul_f32 v83, v83, v221
    v_mul_f32 v84, v84, v223
    v_mul_f32 v85, v85, v223
    v_mul_f32 v86, v86, v223
    v_mul_f32 v87, v87, v223
    v_mul_f32 v88, v88, v225
    v_mul_f32 v89, v89, v225
    v_mul_f32 v90, v90, v225
    v_mul_f32 v91, v91, v225
    v_mul_f32 v92, v92, v227
    v_mul_f32 v93, v93, v227
    v_mul_f32 v94, v94, v227
    v_mul_f32 v95, v95, v227
    v_mul_f32 v96, v96, v221
    v_mul_f32 v97, v97, v221
    v_mul_f32 v98, v98, v221
    v_mul_f32 v99, v99, v221
    v_mul_f32 v100, v100, v223
    v_mul_f32 v101, v101, v223
    v_mul_f32 v102, v102, v223
    v_mul_f32 v103, v103, v223
    v_mul_f32 v104, v104, v225
    v_mul_f32 v105, v105, v225
    v_mul_f32 v106, v106, v225
    v_mul_f32 v107, v107, v225
    v_mul_f32 v108, v108, v227
    v_mul_f32 v109, v109, v227
    v_mul_f32 v110, v110, v227
    v_mul_f32 v111, v111, v227
    v_mul_f32 v112, v112, v221
    v_mul_f32 v113, v113, v221
    v_mul_f32 v114, v114, v221
    v_mul_f32 v115, v115, v221
    v_mul_f32 v116, v116, v223
    v_mul_f32 v117, v117, v223
    v_mul_f32 v118, v118, v223
    v_mul_f32 v119, v119, v223
    v_mul_f32 v120, v120, v225
    v_mul_f32 v121, v121, v225
    v_mul_f32 v122, v122, v225
    v_mul_f32 v123, v123, v225
    v_mul_f32 v124, v124, v227
    v_mul_f32 v125, v125, v227
    v_mul_f32 v126, v126, v227
    v_mul_f32 v127, v127, v227
    v_accvgpr_read_b32 v233, a132
    v_mul_f32 v233, v233, v221
    s_nop 0
    v_accvgpr_write_b32 a132, v233
    v_accvgpr_read_b32 v233, a133
    v_mul_f32 v233, v233, v221
    s_nop 0
    v_accvgpr_write_b32 a133, v233
    v_accvgpr_read_b32 v233, a134
    v_mul_f32 v233, v233, v221
    s_nop 0
    v_accvgpr_write_b32 a134, v233
    v_accvgpr_read_b32 v233, a135
    v_mul_f32 v233, v233, v221
    s_nop 0
    v_accvgpr_write_b32 a135, v233
    v_accvgpr_read_b32 v233, a136
    v_mul_f32 v233, v233, v223
    s_nop 0
    v_accvgpr_write_b32 a136, v233
    v_accvgpr_read_b32 v233, a137
    v_mul_f32 v233, v233, v223
    s_nop 0
    v_accvgpr_write_b32 a137, v233
    v_accvgpr_read_b32 v233, a138
    v_mul_f32 v233, v233, v223
    s_nop 0
    v_accvgpr_write_b32 a138, v233
    v_accvgpr_read_b32 v233, a139
    v_mul_f32 v233, v233, v223
    s_nop 0
    v_accvgpr_write_b32 a139, v233
    v_accvgpr_read_b32 v233, a140
    v_mul_f32 v233, v233, v225
    s_nop 0
    v_accvgpr_write_b32 a140, v233
    v_accvgpr_read_b32 v233, a141
    v_mul_f32 v233, v233, v225
    s_nop 0
    v_accvgpr_write_b32 a141, v233
    v_accvgpr_read_b32 v233, a142
    v_mul_f32 v233, v233, v225
    s_nop 0
    v_accvgpr_write_b32 a142, v233
    v_accvgpr_read_b32 v233, a143
    v_mul_f32 v233, v233, v225
    s_nop 0
    v_accvgpr_write_b32 a143, v233
    v_accvgpr_read_b32 v233, a144
    v_mul_f32 v233, v233, v227
    s_nop 0
    v_accvgpr_write_b32 a144, v233
    v_accvgpr_read_b32 v233, a145
    v_mul_f32 v233, v233, v227
    s_nop 0
    v_accvgpr_write_b32 a145, v233
    v_accvgpr_read_b32 v233, a146
    v_mul_f32 v233, v233, v227
    s_nop 0
    v_accvgpr_write_b32 a146, v233
    v_accvgpr_read_b32 v233, a147
    v_mul_f32 v233, v233, v227
    s_nop 0
    v_accvgpr_write_b32 a147, v233
    s_mov_b32 s27, 0
    s_nop 4
    s_branch L_rcr4
L_rb5:
    s_nop 4
    v_mov_b32 v233, v229
    v_mov_b32 v234, v230
    v_mov_b32 v235, v231
    v_mov_b32 v236, v232
    v_permlane32_swap_b32 v229, v233
    v_permlane32_swap_b32 v230, v234
    v_permlane32_swap_b32 v231, v235
    v_permlane32_swap_b32 v232, v236
    v_max_f32 v229, v229, v233
    v_max_f32 v230, v230, v234
    v_max_f32 v231, v231, v235
    v_max_f32 v232, v232, v236
    v_mov_b32 v233, v229
    v_mov_b32 v234, v230
    v_mov_b32 v235, v231
    v_mov_b32 v236, v232
    v_permlane16_swap_b32 v229, v233
    v_permlane16_swap_b32 v230, v234
    v_permlane16_swap_b32 v231, v235
    v_permlane16_swap_b32 v232, v236
    v_max_f32 v229, v229, v233
    v_max_f32 v230, v230, v234
    v_max_f32 v231, v231, v235
    v_max_f32 v232, v232, v236
    v_subrev_f32 v233, 0x427af233, v217
    v_max_f32 v229, v229, v233
    v_mul_f32 v233, s28, v229
    v_sub_f32 v221, v213, v233
    v_exp_f32 v221, v221
    v_mov_b32 v213, v233
    v_add_f32 v217, 0x427af233, v229
    v_subrev_f32 v234, 0x427af233, v218
    v_max_f32 v230, v230, v234
    v_mul_f32 v234, s28, v230
    v_sub_f32 v223, v214, v234
    v_exp_f32 v223, v223
    v_mov_b32 v214, v234
    v_add_f32 v218, 0x427af233, v230
    v_subrev_f32 v235, 0x427af233, v219
    v_max_f32 v231, v231, v235
    v_mul_f32 v235, s28, v231
    v_sub_f32 v225, v215, v235
    v_exp_f32 v225, v225
    v_mov_b32 v215, v235
    v_add_f32 v219, 0x427af233, v231
    v_subrev_f32 v236, 0x427af233, v220
    v_max_f32 v232, v232, v236
    v_mul_f32 v236, s28, v232
    v_sub_f32 v227, v216, v236
    v_exp_f32 v227, v227
    v_mov_b32 v216, v236
    v_add_f32 v220, 0x427af233, v232
    s_mov_b32 s27, 1
    s_nop 4
    s_branch L_rbr5
L_rc5:
    s_nop 15
    v_mul_f32 v0, v0, v221
    v_mul_f32 v1, v1, v221
    v_mul_f32 v2, v2, v221
    v_mul_f32 v3, v3, v221
    v_mul_f32 v4, v4, v223
    v_mul_f32 v5, v5, v223
    v_mul_f32 v6, v6, v223
    v_mul_f32 v7, v7, v223
    v_mul_f32 v8, v8, v225
    v_mul_f32 v9, v9, v225
    v_mul_f32 v10, v10, v225
    v_mul_f32 v11, v11, v225
    v_mul_f32 v12, v12, v227
    v_mul_f32 v13, v13, v227
    v_mul_f32 v14, v14, v227
    v_mul_f32 v15, v15, v227
    v_mul_f32 v16, v16, v221
    v_mul_f32 v17, v17, v221
    v_mul_f32 v18, v18, v221
    v_mul_f32 v19, v19, v221
    v_mul_f32 v20, v20, v223
    v_mul_f32 v21, v21, v223
    v_mul_f32 v22, v22, v223
    v_mul_f32 v23, v23, v223
    v_mul_f32 v24, v24, v225
    v_mul_f32 v25, v25, v225
    v_mul_f32 v26, v26, v225
    v_mul_f32 v27, v27, v225
    v_mul_f32 v28, v28, v227
    v_mul_f32 v29, v29, v227
    v_mul_f32 v30, v30, v227
    v_mul_f32 v31, v31, v227
    v_mul_f32 v32, v32, v221
    v_mul_f32 v33, v33, v221
    v_mul_f32 v34, v34, v221
    v_mul_f32 v35, v35, v221
    v_mul_f32 v36, v36, v223
    v_mul_f32 v37, v37, v223
    v_mul_f32 v38, v38, v223
    v_mul_f32 v39, v39, v223
    v_mul_f32 v40, v40, v225
    v_mul_f32 v41, v41, v225
    v_mul_f32 v42, v42, v225
    v_mul_f32 v43, v43, v225
    v_mul_f32 v44, v44, v227
    v_mul_f32 v45, v45, v227
    v_mul_f32 v46, v46, v227
    v_mul_f32 v47, v47, v227
    v_mul_f32 v48, v48, v221
    v_mul_f32 v49, v49, v221
    v_mul_f32 v50, v50, v221
    v_mul_f32 v51, v51, v221
    v_mul_f32 v52, v52, v223
    v_mul_f32 v53, v53, v223
    v_mul_f32 v54, v54, v223
    v_mul_f32 v55, v55, v223
    v_mul_f32 v56, v56, v225
    v_mul_f32 v57, v57, v225
    v_mul_f32 v58, v58, v225
    v_mul_f32 v59, v59, v225
    v_mul_f32 v60, v60, v227
    v_mul_f32 v61, v61, v227
    v_mul_f32 v62, v62, v227
    v_mul_f32 v63, v63, v227
    v_mul_f32 v64, v64, v221
    v_mul_f32 v65, v65, v221
    v_mul_f32 v66, v66, v221
    v_mul_f32 v67, v67, v221
    v_mul_f32 v68, v68, v223
    v_mul_f32 v69, v69, v223
    v_mul_f32 v70, v70, v223
    v_mul_f32 v71, v71, v223
    v_mul_f32 v72, v72, v225
    v_mul_f32 v73, v73, v225
    v_mul_f32 v74, v74, v225
    v_mul_f32 v75, v75, v225
    v_mul_f32 v76, v76, v227
    v_mul_f32 v77, v77, v227
    v_mul_f32 v78, v78, v227
    v_mul_f32 v79, v79, v227
    v_mul_f32 v80, v80, v221
    v_mul_f32 v81, v81, v221
    v_mul_f32 v82, v82, v221
    v_mul_f32 v83, v83, v221
    v_mul_f32 v84, v84, v223
    v_mul_f32 v85, v85, v223
    v_mul_f32 v86, v86, v223
    v_mul_f32 v87, v87, v223
    v_mul_f32 v88, v88, v225
    v_mul_f32 v89, v89, v225
    v_mul_f32 v90, v90, v225
    v_mul_f32 v91, v91, v225
    v_mul_f32 v92, v92, v227
    v_mul_f32 v93, v93, v227
    v_mul_f32 v94, v94, v227
    v_mul_f32 v95, v95, v227
    v_mul_f32 v96, v96, v221
    v_mul_f32 v97, v97, v221
    v_mul_f32 v98, v98, v221
    v_mul_f32 v99, v99, v221
    v_mul_f32 v100, v100, v223
    v_mul_f32 v101, v101, v223
    v_mul_f32 v102, v102, v223
    v_mul_f32 v103, v103, v223
    v_mul_f32 v104, v104, v225
    v_mul_f32 v105, v105, v225
    v_mul_f32 v106, v106, v225
    v_mul_f32 v107, v107, v225
    v_mul_f32 v108, v108, v227
    v_mul_f32 v109, v109, v227
    v_mul_f32 v110, v110, v227
    v_mul_f32 v111, v111, v227
    v_mul_f32 v112, v112, v221
    v_mul_f32 v113, v113, v221
    v_mul_f32 v114, v114, v221
    v_mul_f32 v115, v115, v221
    v_mul_f32 v116, v116, v223
    v_mul_f32 v117, v117, v223
    v_mul_f32 v118, v118, v223
    v_mul_f32 v119, v119, v223
    v_mul_f32 v120, v120, v225
    v_mul_f32 v121, v121, v225
    v_mul_f32 v122, v122, v225
    v_mul_f32 v123, v123, v225
    v_mul_f32 v124, v124, v227
    v_mul_f32 v125, v125, v227
    v_mul_f32 v126, v126, v227
    v_mul_f32 v127, v127, v227
    v_accvgpr_read_b32 v233, a132
    v_mul_f32 v233, v233, v221
    s_nop 0
    v_accvgpr_write_b32 a132, v233
    v_accvgpr_read_b32 v233, a133
    v_mul_f32 v233, v233, v221
    s_nop 0
    v_accvgpr_write_b32 a133, v233
    v_accvgpr_read_b32 v233, a134
    v_mul_f32 v233, v233, v221
    s_nop 0
    v_accvgpr_write_b32 a134, v233
    v_accvgpr_read_b32 v233, a135
    v_mul_f32 v233, v233, v221
    s_nop 0
    v_accvgpr_write_b32 a135, v233
    v_accvgpr_read_b32 v233, a136
    v_mul_f32 v233, v233, v223
    s_nop 0
    v_accvgpr_write_b32 a136, v233
    v_accvgpr_read_b32 v233, a137
    v_mul_f32 v233, v233, v223
    s_nop 0
    v_accvgpr_write_b32 a137, v233
    v_accvgpr_read_b32 v233, a138
    v_mul_f32 v233, v233, v223
    s_nop 0
    v_accvgpr_write_b32 a138, v233
    v_accvgpr_read_b32 v233, a139
    v_mul_f32 v233, v233, v223
    s_nop 0
    v_accvgpr_write_b32 a139, v233
    v_accvgpr_read_b32 v233, a140
    v_mul_f32 v233, v233, v225
    s_nop 0
    v_accvgpr_write_b32 a140, v233
    v_accvgpr_read_b32 v233, a141
    v_mul_f32 v233, v233, v225
    s_nop 0
    v_accvgpr_write_b32 a141, v233
    v_accvgpr_read_b32 v233, a142
    v_mul_f32 v233, v233, v225
    s_nop 0
    v_accvgpr_write_b32 a142, v233
    v_accvgpr_read_b32 v233, a143
    v_mul_f32 v233, v233, v225
    s_nop 0
    v_accvgpr_write_b32 a143, v233
    v_accvgpr_read_b32 v233, a144
    v_mul_f32 v233, v233, v227
    s_nop 0
    v_accvgpr_write_b32 a144, v233
    v_accvgpr_read_b32 v233, a145
    v_mul_f32 v233, v233, v227
    s_nop 0
    v_accvgpr_write_b32 a145, v233
    v_accvgpr_read_b32 v233, a146
    v_mul_f32 v233, v233, v227
    s_nop 0
    v_accvgpr_write_b32 a146, v233
    v_accvgpr_read_b32 v233, a147
    v_mul_f32 v233, v233, v227
    s_nop 0
    v_accvgpr_write_b32 a147, v233
    s_mov_b32 s27, 0
    s_nop 4
    s_branch L_rcr5
L_rb6:
    s_nop 4
    v_mov_b32 v233, v229
    v_mov_b32 v234, v230
    v_mov_b32 v235, v231
    v_mov_b32 v236, v232
    v_permlane32_swap_b32 v229, v233
    v_permlane32_swap_b32 v230, v234
    v_permlane32_swap_b32 v231, v235
    v_permlane32_swap_b32 v232, v236
    v_max_f32 v229, v229, v233
    v_max_f32 v230, v230, v234
    v_max_f32 v231, v231, v235
    v_max_f32 v232, v232, v236
    v_mov_b32 v233, v229
    v_mov_b32 v234, v230
    v_mov_b32 v235, v231
    v_mov_b32 v236, v232
    v_permlane16_swap_b32 v229, v233
    v_permlane16_swap_b32 v230, v234
    v_permlane16_swap_b32 v231, v235
    v_permlane16_swap_b32 v232, v236
    v_max_f32 v229, v229, v233
    v_max_f32 v230, v230, v234
    v_max_f32 v231, v231, v235
    v_max_f32 v232, v232, v236
    v_subrev_f32 v233, 0x427af233, v217
    v_max_f32 v229, v229, v233
    v_mul_f32 v233, s28, v229
    v_sub_f32 v221, v213, v233
    v_exp_f32 v221, v221
    v_mov_b32 v213, v233
    v_add_f32 v217, 0x427af233, v229
    v_subrev_f32 v234, 0x427af233, v218
    v_max_f32 v230, v230, v234
    v_mul_f32 v234, s28, v230
    v_sub_f32 v223, v214, v234
    v_exp_f32 v223, v223
    v_mov_b32 v214, v234
    v_add_f32 v218, 0x427af233, v230
    v_subrev_f32 v235, 0x427af233, v219
    v_max_f32 v231, v231, v235
    v_mul_f32 v235, s28, v231
    v_sub_f32 v225, v215, v235
    v_exp_f32 v225, v225
    v_mov_b32 v215, v235
    v_add_f32 v219, 0x427af233, v231
    v_subrev_f32 v236, 0x427af233, v220
    v_max_f32 v232, v232, v236
    v_mul_f32 v236, s28, v232
    v_sub_f32 v227, v216, v236
    v_exp_f32 v227, v227
    v_mov_b32 v216, v236
    v_add_f32 v220, 0x427af233, v232
    s_mov_b32 s27, 1
    s_nop 4
    s_branch L_rbr6
L_rc6:
    s_nop 15
    v_mul_f32 v0, v0, v221
    v_mul_f32 v1, v1, v221
    v_mul_f32 v2, v2, v221
    v_mul_f32 v3, v3, v221
    v_mul_f32 v4, v4, v223
    v_mul_f32 v5, v5, v223
    v_mul_f32 v6, v6, v223
    v_mul_f32 v7, v7, v223
    v_mul_f32 v8, v8, v225
    v_mul_f32 v9, v9, v225
    v_mul_f32 v10, v10, v225
    v_mul_f32 v11, v11, v225
    v_mul_f32 v12, v12, v227
    v_mul_f32 v13, v13, v227
    v_mul_f32 v14, v14, v227
    v_mul_f32 v15, v15, v227
    v_mul_f32 v16, v16, v221
    v_mul_f32 v17, v17, v221
    v_mul_f32 v18, v18, v221
    v_mul_f32 v19, v19, v221
    v_mul_f32 v20, v20, v223
    v_mul_f32 v21, v21, v223
    v_mul_f32 v22, v22, v223
    v_mul_f32 v23, v23, v223
    v_mul_f32 v24, v24, v225
    v_mul_f32 v25, v25, v225
    v_mul_f32 v26, v26, v225
    v_mul_f32 v27, v27, v225
    v_mul_f32 v28, v28, v227
    v_mul_f32 v29, v29, v227
    v_mul_f32 v30, v30, v227
    v_mul_f32 v31, v31, v227
    v_mul_f32 v32, v32, v221
    v_mul_f32 v33, v33, v221
    v_mul_f32 v34, v34, v221
    v_mul_f32 v35, v35, v221
    v_mul_f32 v36, v36, v223
    v_mul_f32 v37, v37, v223
    v_mul_f32 v38, v38, v223
    v_mul_f32 v39, v39, v223
    v_mul_f32 v40, v40, v225
    v_mul_f32 v41, v41, v225
    v_mul_f32 v42, v42, v225
    v_mul_f32 v43, v43, v225
    v_mul_f32 v44, v44, v227
    v_mul_f32 v45, v45, v227
    v_mul_f32 v46, v46, v227
    v_mul_f32 v47, v47, v227
    v_mul_f32 v48, v48, v221
    v_mul_f32 v49, v49, v221
    v_mul_f32 v50, v50, v221
    v_mul_f32 v51, v51, v221
    v_mul_f32 v52, v52, v223
    v_mul_f32 v53, v53, v223
    v_mul_f32 v54, v54, v223
    v_mul_f32 v55, v55, v223
    v_mul_f32 v56, v56, v225
    v_mul_f32 v57, v57, v225
    v_mul_f32 v58, v58, v225
    v_mul_f32 v59, v59, v225
    v_mul_f32 v60, v60, v227
    v_mul_f32 v61, v61, v227
    v_mul_f32 v62, v62, v227
    v_mul_f32 v63, v63, v227
    v_mul_f32 v64, v64, v221
    v_mul_f32 v65, v65, v221
    v_mul_f32 v66, v66, v221
    v_mul_f32 v67, v67, v221
    v_mul_f32 v68, v68, v223
    v_mul_f32 v69, v69, v223
    v_mul_f32 v70, v70, v223
    v_mul_f32 v71, v71, v223
    v_mul_f32 v72, v72, v225
    v_mul_f32 v73, v73, v225
    v_mul_f32 v74, v74, v225
    v_mul_f32 v75, v75, v225
    v_mul_f32 v76, v76, v227
    v_mul_f32 v77, v77, v227
    v_mul_f32 v78, v78, v227
    v_mul_f32 v79, v79, v227
    v_mul_f32 v80, v80, v221
    v_mul_f32 v81, v81, v221
    v_mul_f32 v82, v82, v221
    v_mul_f32 v83, v83, v221
    v_mul_f32 v84, v84, v223
    v_mul_f32 v85, v85, v223
    v_mul_f32 v86, v86, v223
    v_mul_f32 v87, v87, v223
    v_mul_f32 v88, v88, v225
    v_mul_f32 v89, v89, v225
    v_mul_f32 v90, v90, v225
    v_mul_f32 v91, v91, v225
    v_mul_f32 v92, v92, v227
    v_mul_f32 v93, v93, v227
    v_mul_f32 v94, v94, v227
    v_mul_f32 v95, v95, v227
    v_mul_f32 v96, v96, v221
    v_mul_f32 v97, v97, v221
    v_mul_f32 v98, v98, v221
    v_mul_f32 v99, v99, v221
    v_mul_f32 v100, v100, v223
    v_mul_f32 v101, v101, v223
    v_mul_f32 v102, v102, v223
    v_mul_f32 v103, v103, v223
    v_mul_f32 v104, v104, v225
    v_mul_f32 v105, v105, v225
    v_mul_f32 v106, v106, v225
    v_mul_f32 v107, v107, v225
    v_mul_f32 v108, v108, v227
    v_mul_f32 v109, v109, v227
    v_mul_f32 v110, v110, v227
    v_mul_f32 v111, v111, v227
    v_mul_f32 v112, v112, v221
    v_mul_f32 v113, v113, v221
    v_mul_f32 v114, v114, v221
    v_mul_f32 v115, v115, v221
    v_mul_f32 v116, v116, v223
    v_mul_f32 v117, v117, v223
    v_mul_f32 v118, v118, v223
    v_mul_f32 v119, v119, v223
    v_mul_f32 v120, v120, v225
    v_mul_f32 v121, v121, v225
    v_mul_f32 v122, v122, v225
    v_mul_f32 v123, v123, v225
    v_mul_f32 v124, v124, v227
    v_mul_f32 v125, v125, v227
    v_mul_f32 v126, v126, v227
    v_mul_f32 v127, v127, v227
    v_accvgpr_read_b32 v233, a132
    v_mul_f32 v233, v233, v221
    s_nop 0
    v_accvgpr_write_b32 a132, v233
    v_accvgpr_read_b32 v233, a133
    v_mul_f32 v233, v233, v221
    s_nop 0
    v_accvgpr_write_b32 a133, v233
    v_accvgpr_read_b32 v233, a134
    v_mul_f32 v233, v233, v221
    s_nop 0
    v_accvgpr_write_b32 a134, v233
    v_accvgpr_read_b32 v233, a135
    v_mul_f32 v233, v233, v221
    s_nop 0
    v_accvgpr_write_b32 a135, v233
    v_accvgpr_read_b32 v233, a136
    v_mul_f32 v233, v233, v223
    s_nop 0
    v_accvgpr_write_b32 a136, v233
    v_accvgpr_read_b32 v233, a137
    v_mul_f32 v233, v233, v223
    s_nop 0
    v_accvgpr_write_b32 a137, v233
    v_accvgpr_read_b32 v233, a138
    v_mul_f32 v233, v233, v223
    s_nop 0
    v_accvgpr_write_b32 a138, v233
    v_accvgpr_read_b32 v233, a139
    v_mul_f32 v233, v233, v223
    s_nop 0
    v_accvgpr_write_b32 a139, v233
    v_accvgpr_read_b32 v233, a140
    v_mul_f32 v233, v233, v225
    s_nop 0
    v_accvgpr_write_b32 a140, v233
    v_accvgpr_read_b32 v233, a141
    v_mul_f32 v233, v233, v225
    s_nop 0
    v_accvgpr_write_b32 a141, v233
    v_accvgpr_read_b32 v233, a142
    v_mul_f32 v233, v233, v225
    s_nop 0
    v_accvgpr_write_b32 a142, v233
    v_accvgpr_read_b32 v233, a143
    v_mul_f32 v233, v233, v225
    s_nop 0
    v_accvgpr_write_b32 a143, v233
    v_accvgpr_read_b32 v233, a144
    v_mul_f32 v233, v233, v227
    s_nop 0
    v_accvgpr_write_b32 a144, v233
    v_accvgpr_read_b32 v233, a145
    v_mul_f32 v233, v233, v227
    s_nop 0
    v_accvgpr_write_b32 a145, v233
    v_accvgpr_read_b32 v233, a146
    v_mul_f32 v233, v233, v227
    s_nop 0
    v_accvgpr_write_b32 a146, v233
    v_accvgpr_read_b32 v233, a147
    v_mul_f32 v233, v233, v227
    s_nop 0
    v_accvgpr_write_b32 a147, v233
    s_mov_b32 s27, 0
    s_nop 4
    s_branch L_rcr6
L_rb7:
    s_nop 4
    v_mov_b32 v233, v229
    v_mov_b32 v234, v230
    v_mov_b32 v235, v231
    v_mov_b32 v236, v232
    v_permlane32_swap_b32 v229, v233
    v_permlane32_swap_b32 v230, v234
    v_permlane32_swap_b32 v231, v235
    v_permlane32_swap_b32 v232, v236
    v_max_f32 v229, v229, v233
    v_max_f32 v230, v230, v234
    v_max_f32 v231, v231, v235
    v_max_f32 v232, v232, v236
    v_mov_b32 v233, v229
    v_mov_b32 v234, v230
    v_mov_b32 v235, v231
    v_mov_b32 v236, v232
    v_permlane16_swap_b32 v229, v233
    v_permlane16_swap_b32 v230, v234
    v_permlane16_swap_b32 v231, v235
    v_permlane16_swap_b32 v232, v236
    v_max_f32 v229, v229, v233
    v_max_f32 v230, v230, v234
    v_max_f32 v231, v231, v235
    v_max_f32 v232, v232, v236
    v_subrev_f32 v233, 0x427af233, v217
    v_max_f32 v229, v229, v233
    v_mul_f32 v233, s28, v229
    v_sub_f32 v221, v213, v233
    v_exp_f32 v221, v221
    v_mov_b32 v213, v233
    v_add_f32 v217, 0x427af233, v229
    v_subrev_f32 v234, 0x427af233, v218
    v_max_f32 v230, v230, v234
    v_mul_f32 v234, s28, v230
    v_sub_f32 v223, v214, v234
    v_exp_f32 v223, v223
    v_mov_b32 v214, v234
    v_add_f32 v218, 0x427af233, v230
    v_subrev_f32 v235, 0x427af233, v219
    v_max_f32 v231, v231, v235
    v_mul_f32 v235, s28, v231
    v_sub_f32 v225, v215, v235
    v_exp_f32 v225, v225
    v_mov_b32 v215, v235
    v_add_f32 v219, 0x427af233, v231
    v_subrev_f32 v236, 0x427af233, v220
    v_max_f32 v232, v232, v236
    v_mul_f32 v236, s28, v232
    v_sub_f32 v227, v216, v236
    v_exp_f32 v227, v227
    v_mov_b32 v216, v236
    v_add_f32 v220, 0x427af233, v232
    s_mov_b32 s27, 1
    s_nop 4
    s_branch L_rbr7
L_rc7:
    s_nop 15
    v_mul_f32 v0, v0, v221
    v_mul_f32 v1, v1, v221
    v_mul_f32 v2, v2, v221
    v_mul_f32 v3, v3, v221
    v_mul_f32 v4, v4, v223
    v_mul_f32 v5, v5, v223
    v_mul_f32 v6, v6, v223
    v_mul_f32 v7, v7, v223
    v_mul_f32 v8, v8, v225
    v_mul_f32 v9, v9, v225
    v_mul_f32 v10, v10, v225
    v_mul_f32 v11, v11, v225
    v_mul_f32 v12, v12, v227
    v_mul_f32 v13, v13, v227
    v_mul_f32 v14, v14, v227
    v_mul_f32 v15, v15, v227
    v_mul_f32 v16, v16, v221
    v_mul_f32 v17, v17, v221
    v_mul_f32 v18, v18, v221
    v_mul_f32 v19, v19, v221
    v_mul_f32 v20, v20, v223
    v_mul_f32 v21, v21, v223
    v_mul_f32 v22, v22, v223
    v_mul_f32 v23, v23, v223
    v_mul_f32 v24, v24, v225
    v_mul_f32 v25, v25, v225
    v_mul_f32 v26, v26, v225
    v_mul_f32 v27, v27, v225
    v_mul_f32 v28, v28, v227
    v_mul_f32 v29, v29, v227
    v_mul_f32 v30, v30, v227
    v_mul_f32 v31, v31, v227
    v_mul_f32 v32, v32, v221
    v_mul_f32 v33, v33, v221
    v_mul_f32 v34, v34, v221
    v_mul_f32 v35, v35, v221
    v_mul_f32 v36, v36, v223
    v_mul_f32 v37, v37, v223
    v_mul_f32 v38, v38, v223
    v_mul_f32 v39, v39, v223
    v_mul_f32 v40, v40, v225
    v_mul_f32 v41, v41, v225
    v_mul_f32 v42, v42, v225
    v_mul_f32 v43, v43, v225
    v_mul_f32 v44, v44, v227
    v_mul_f32 v45, v45, v227
    v_mul_f32 v46, v46, v227
    v_mul_f32 v47, v47, v227
    v_mul_f32 v48, v48, v221
    v_mul_f32 v49, v49, v221
    v_mul_f32 v50, v50, v221
    v_mul_f32 v51, v51, v221
    v_mul_f32 v52, v52, v223
    v_mul_f32 v53, v53, v223
    v_mul_f32 v54, v54, v223
    v_mul_f32 v55, v55, v223
    v_mul_f32 v56, v56, v225
    v_mul_f32 v57, v57, v225
    v_mul_f32 v58, v58, v225
    v_mul_f32 v59, v59, v225
    v_mul_f32 v60, v60, v227
    v_mul_f32 v61, v61, v227
    v_mul_f32 v62, v62, v227
    v_mul_f32 v63, v63, v227
    v_mul_f32 v64, v64, v221
    v_mul_f32 v65, v65, v221
    v_mul_f32 v66, v66, v221
    v_mul_f32 v67, v67, v221
    v_mul_f32 v68, v68, v223
    v_mul_f32 v69, v69, v223
    v_mul_f32 v70, v70, v223
    v_mul_f32 v71, v71, v223
    v_mul_f32 v72, v72, v225
    v_mul_f32 v73, v73, v225
    v_mul_f32 v74, v74, v225
    v_mul_f32 v75, v75, v225
    v_mul_f32 v76, v76, v227
    v_mul_f32 v77, v77, v227
    v_mul_f32 v78, v78, v227
    v_mul_f32 v79, v79, v227
    v_mul_f32 v80, v80, v221
    v_mul_f32 v81, v81, v221
    v_mul_f32 v82, v82, v221
    v_mul_f32 v83, v83, v221
    v_mul_f32 v84, v84, v223
    v_mul_f32 v85, v85, v223
    v_mul_f32 v86, v86, v223
    v_mul_f32 v87, v87, v223
    v_mul_f32 v88, v88, v225
    v_mul_f32 v89, v89, v225
    v_mul_f32 v90, v90, v225
    v_mul_f32 v91, v91, v225
    v_mul_f32 v92, v92, v227
    v_mul_f32 v93, v93, v227
    v_mul_f32 v94, v94, v227
    v_mul_f32 v95, v95, v227
    v_mul_f32 v96, v96, v221
    v_mul_f32 v97, v97, v221
    v_mul_f32 v98, v98, v221
    v_mul_f32 v99, v99, v221
    v_mul_f32 v100, v100, v223
    v_mul_f32 v101, v101, v223
    v_mul_f32 v102, v102, v223
    v_mul_f32 v103, v103, v223
    v_mul_f32 v104, v104, v225
    v_mul_f32 v105, v105, v225
    v_mul_f32 v106, v106, v225
    v_mul_f32 v107, v107, v225
    v_mul_f32 v108, v108, v227
    v_mul_f32 v109, v109, v227
    v_mul_f32 v110, v110, v227
    v_mul_f32 v111, v111, v227
    v_mul_f32 v112, v112, v221
    v_mul_f32 v113, v113, v221
    v_mul_f32 v114, v114, v221
    v_mul_f32 v115, v115, v221
    v_mul_f32 v116, v116, v223
    v_mul_f32 v117, v117, v223
    v_mul_f32 v118, v118, v223
    v_mul_f32 v119, v119, v223
    v_mul_f32 v120, v120, v225
    v_mul_f32 v121, v121, v225
    v_mul_f32 v122, v122, v225
    v_mul_f32 v123, v123, v225
    v_mul_f32 v124, v124, v227
    v_mul_f32 v125, v125, v227
    v_mul_f32 v126, v126, v227
    v_mul_f32 v127, v127, v227
    v_accvgpr_read_b32 v233, a132
    v_mul_f32 v233, v233, v221
    s_nop 0
    v_accvgpr_write_b32 a132, v233
    v_accvgpr_read_b32 v233, a133
    v_mul_f32 v233, v233, v221
    s_nop 0
    v_accvgpr_write_b32 a133, v233
    v_accvgpr_read_b32 v233, a134
    v_mul_f32 v233, v233, v221
    s_nop 0
    v_accvgpr_write_b32 a134, v233
    v_accvgpr_read_b32 v233, a135
    v_mul_f32 v233, v233, v221
    s_nop 0
    v_accvgpr_write_b32 a135, v233
    v_accvgpr_read_b32 v233, a136
    v_mul_f32 v233, v233, v223
    s_nop 0
    v_accvgpr_write_b32 a136, v233
    v_accvgpr_read_b32 v233, a137
    v_mul_f32 v233, v233, v223
    s_nop 0
    v_accvgpr_write_b32 a137, v233
    v_accvgpr_read_b32 v233, a138
    v_mul_f32 v233, v233, v223
    s_nop 0
    v_accvgpr_write_b32 a138, v233
    v_accvgpr_read_b32 v233, a139
    v_mul_f32 v233, v233, v223
    s_nop 0
    v_accvgpr_write_b32 a139, v233
    v_accvgpr_read_b32 v233, a140
    v_mul_f32 v233, v233, v225
    s_nop 0
    v_accvgpr_write_b32 a140, v233
    v_accvgpr_read_b32 v233, a141
    v_mul_f32 v233, v233, v225
    s_nop 0
    v_accvgpr_write_b32 a141, v233
    v_accvgpr_read_b32 v233, a142
    v_mul_f32 v233, v233, v225
    s_nop 0
    v_accvgpr_write_b32 a142, v233
    v_accvgpr_read_b32 v233, a143
    v_mul_f32 v233, v233, v225
    s_nop 0
    v_accvgpr_write_b32 a143, v233
    v_accvgpr_read_b32 v233, a144
    v_mul_f32 v233, v233, v227
    s_nop 0
    v_accvgpr_write_b32 a144, v233
    v_accvgpr_read_b32 v233, a145
    v_mul_f32 v233, v233, v227
    s_nop 0
    v_accvgpr_write_b32 a145, v233
    v_accvgpr_read_b32 v233, a146
    v_mul_f32 v233, v233, v227
    s_nop 0
    v_accvgpr_write_b32 a146, v233
    v_accvgpr_read_b32 v233, a147
    v_mul_f32 v233, v233, v227
    s_nop 0
    v_accvgpr_write_b32 a147, v233
    s_mov_b32 s27, 0
    s_nop 4
    s_branch L_rcr7
.section .rodata,"a"
.p2align 6
.amdhsa_kernel standalone__gqa_softmax__near_ridge_kernel
  .amdhsa_next_free_vgpr 512
  .amdhsa_next_free_sgpr 100
  .amdhsa_accum_offset 256
  .amdhsa_group_segment_fixed_size 0
  .amdhsa_kernarg_size 48
  .amdhsa_user_sgpr_count 2
  .amdhsa_user_sgpr_kernarg_segment_ptr 1
  .amdhsa_system_sgpr_workgroup_id_x 1
.end_amdhsa_kernel
```
